```python
import torch

def _softmax(x, axis=-1):
    return torch.softmax(x, dim=axis)
def _gelu(x):
    return torch.nn.functional.gelu(x, approximate="tanh")
def _silu(x):
    return torch.nn.functional.silu(x)
def _sigmoid(x):
    return torch.sigmoid(x)
def _layernorm(x, axis=-1, eps=1e-5):
    m = x.mean(dim=axis, keepdim=True)
    v = x.var(dim=axis, keepdim=True, unbiased=False)
    return (x - m) / torch.sqrt(v + eps)
def _scatter_add(tgt, idx, src, axis=0):
    return tgt.clone().index_add_(axis, idx, src)
def _segment_sum(src, seg, n):
    out = torch.zeros((n,) + src.shape[1:], dtype=src.dtype)
    return out.index_add_(0, seg, src)
def _pad(x, pw):
    flat = tuple(v for pair in reversed(pw) for v in pair)
    return torch.nn.functional.pad(x, flat)

kernel_name = 'gated_mix__mha_block__sliding_block__prompt'

def setup_inputs():

    _w = (lambda a: (lambda t: t.to(torch.bfloat16) if t.is_floating_point() else t)(torch.as_tensor(a)))
    def _A_setup():
        B, S, D, H = 1, 2048, 640, 32
        return {
            "x": _w((lambda *s: torch.randn(*s, dtype=torch.bfloat16) * 0.05)(B, S, D)),
            "wqkv": _w((lambda *s: torch.randn(*s, dtype=torch.bfloat16) * 3.2)(D, 3 * D)),
            "wo": _w((lambda *s: torch.randn(*s, dtype=torch.bfloat16) * 0.1)(D, D)),
        }
    _A_in = _A_setup()

    def _B_setup():
        B, S, D = 1, 2048, 640
        return {
            "x": _w((lambda *s: torch.randn(*s, dtype=torch.bfloat16) * 0.05)(B, S, D)),
            "wqkv": _w((lambda *s: torch.randn(*s, dtype=torch.bfloat16) * 3.2)(D, 3 * D)),
            "wo": _w((lambda *s: torch.randn(*s, dtype=torch.bfloat16) * 0.1)(D, D)),
        }
    _B_in = _B_setup()

    return {
        "A_x": _A_in["x"],
        "A_wqkv": _A_in["wqkv"],
        "A_wo": _A_in["wo"],
        "B_x": _B_in["x"],
        "B_wqkv": _B_in["wqkv"],
        "B_wo": _B_in["wo"],
        "gate_w": _w((lambda *s: torch.randn(*s, dtype=torch.bfloat16) * 0.05)(640) * 16.0),
    }

def reference(A_x, A_wqkv, A_wo, B_x, B_wqkv, B_wo, gate_w):
    def _A_ref(x, wqkv, wo):
        B, S, D = x.shape
        H = 32
        Dh = D // H
        qkv = (lambda x, *d: x.permute(*d))((x @ wqkv).reshape(B, S, 3, H, Dh), 2, 0, 3, 1, 4)
        q, k, v = qkv[0], qkv[1], qkv[2]
        scores = torch.einsum("bhqd,bhkd->bhqk", q, k) * (Dh ** -0.5)
        p = _softmax(scores, axis=-1)
        o = torch.einsum("bhqk,bhkd->bhqd", p, v)
        return (lambda x, *d: x.permute(*d))(o, 0, 2, 1, 3).reshape(B, S, D) @ wo

    def _B_ref(x, wqkv, wo):
        B, S, D = x.shape
        H = 32; Dh = D // H; W = 256
        qkv = (lambda x, *d: x.permute(*d))((x @ wqkv).reshape(B, S, 3, H, Dh), 2, 0, 3, 1, 4)
        q, k, v = qkv[0], qkv[1], qkv[2]
        scores = torch.einsum("bhqd,bhkd->bhqk", q, k) * (Dh ** -0.5)
        idx = torch.arange(S)
        mask = (idx[:, None] - idx[None, :] >= 0) & (idx[:, None] - idx[None, :] < W)
        scores = torch.where(mask[None, None], scores, -1e9)
        p = _softmax(scores, axis=-1)
        o = torch.einsum("bhqk,bhkd->bhqd", p, v)
        return (lambda x, *d: x.permute(*d))(o, 0, 2, 1, 3).reshape(B, S, D) @ wo

    x = A_x
    g = _sigmoid((x * gate_w).sum(-1, keepdims=True))
    a = _A_ref(x, A_wqkv, A_wo)
    b = _B_ref(x, B_wqkv, B_wo)
    return g * a + (1 - g) * b
```

```asm
; @launch kernel=qkv_kernel grid=(256,1,1) block=(512,1,1) lds=147456
; @launch kernel=attn_kernel grid=(256,1,1) block=(512,1,1) lds=107008
; @launch kernel=oproj_kernel grid=(256,1,1) block=(512,1,1) lds=151552
.amdgcn_target "amdgcn-amd-amdhsa--gfx950"
.text
.globl qkv_kernel
.p2align 8
.type qkv_kernel,@function
qkv_kernel:
    s_cmp_ge_u32 s2, 256
    s_cbranch_scc1 K1_END
    s_load_dwordx4 s[4:7], s[0:1], 0
    s_load_dwordx4 s[8:11], s[0:1], 24
    s_load_dwordx2 s[24:25], s[0:1], 48
    s_load_dwordx2 s[26:27], s[0:1], 72
    s_load_dwordx2 s[40:41], s[0:1], 16
    s_load_dwordx2 s[42:43], s[0:1], 40
    v_and_b32 v1, 63, v0
    v_lshrrev_b32 v2, 6, v0
    s_nop 0
    v_readfirstlane_b32 s28, v2
    s_waitcnt lgkmcnt(0)
    s_mov_b32 s20, s26
    s_and_b32 s21, s27, 0xffff
    s_mov_b32 s22, 0x1800000
    s_mov_b32 s23, 0x00020000
    s_and_b32 s29, s2, 7
    s_lshr_b32 s30, s2, 3
    s_and_b32 s33, s30, 3
    s_lshr_b32 s34, s30, 2
    s_lshr_b32 s35, s29, 1
    s_and_b32 s29, s29, 1
    s_cmp_ge_u32 s35, 2
    s_cselect_b32 s36, 1, 0
    s_cmp_eq_u32 s34, 7
    s_cselect_b32 s37, 1, 0
    s_and_b32 s36, s36, s37
    s_lshl_b32 s38, s29, 2
    s_add_u32 s38, s38, s33
    s_cmp_eq_u32 s36, 1
    s_cbranch_scc0 K1_MAIN
    s_sub_u32 s39, s35, 2
    s_lshl_b32 s39, s39, 3
    s_add_u32 s39, s39, s38
    s_branch K1_GATE
K1_MAIN:
    s_mov_b32 s29, s38
    s_lshl_b32 s30, s35, 3
    s_cmp_eq_u32 s35, 3
    s_cselect_b32 s30, 23, s30
    s_add_u32 s30, s30, s34
    s_cmp_ge_u32 s30, 15
    s_cselect_b32 s31, 1, 0
    s_cselect_b32 s6, s10, s6
    s_cselect_b32 s7, s11, s7
    s_mul_i32 s32, s31, 15
    s_sub_u32 s32, s30, s32
    s_mov_b32 s12, s4
    s_and_b32 s13, s5, 0xffff
    s_mov_b32 s14, 0x280000
    s_mov_b32 s15, 0x00020000
    s_mov_b32 s16, s6
    s_and_b32 s17, s7, 0xffff
    s_mov_b32 s18, 0x258000
    s_mov_b32 s19, 0x00020000
    s_and_b32 s34, s28, 3
    s_lshr_b32 s35, s28, 2
    v_lshrrev_b32 v3, 3, v1
    v_and_b32 v4, 7, v1
    v_lshrrev_b32 v5, 4, v1
    s_lshl_b32 s33, s29, 8
    s_lshl_b32 s36, s28, 5
    s_add_u32 s33, s33, s36
    v_add_u32 v6, s33, v3
    v_mul_u32_u24 v6, 1280, v6
    v_xor_b32 v7, v4, v5
    v_lshl_add_u32 v200, v7, 4, v6
    v_xor_b32 v7, 4, v7
    v_lshl_add_u32 v201, v7, 4, v6
    v_and_b32 v4, 15, v1
    v_lshlrev_b32 v6, 2, v5
    v_xor_b32 v4, v4, v6
    s_lshl_b32 s33, s28, 3
    v_add_u32 v6, s33, v5
    v_mul_u32_u24 v6, 3840, v6
    v_lshl_add_u32 v6, v4, 4, v6
    s_lshl_b32 s33, s32, 8
    v_add_u32 v203, s33, v6
    v_and_b32 v3, 31, v1
    v_lshrrev_b32 v4, 5, v1
    v_bfe_u32 v5, v1, 1, 3
    s_lshl_b32 s33, s34, 6
    v_add_u32 v6, s33, v3
    v_lshlrev_b32 v6, 7, v6
    v_add_u32 v7, 0, v4
    v_xor_b32 v7, v7, v5
    v_lshl_add_u32 v204, v7, 4, v6
    v_add_u32 v7, 2, v4
    v_xor_b32 v7, v7, v5
    v_lshl_add_u32 v205, v7, 4, v6
    v_add_u32 v7, 4, v4
    v_xor_b32 v7, v7, v5
    v_lshl_add_u32 v206, v7, 4, v6
    v_add_u32 v7, 6, v4
    v_xor_b32 v7, v7, v5
    v_lshl_add_u32 v207, v7, 4, v6
    v_lshrrev_b32 v5, 4, v1
    v_bfe_u32 v6, v1, 2, 2
    v_and_b32 v7, 3, v1
    v_lshrrev_b32 v8, 1, v5
    v_lshl_add_u32 v8, v8, 3, v6
    v_lshlrev_b32 v8, 8, v8
    v_and_b32 v9, 1, v5
    v_lshl_add_u32 v8, v9, 5, v8
    v_lshl_add_u32 v8, v7, 3, v8
    v_add_u32 v8, 32768, v8
    s_lshl_b32 s33, s35, 1
    v_mov_b32 v9, s33
    v_xor_b32 v9, v9, v6
    v_lshl_add_u32 v208, v9, 6, v8
    v_mov_b32 v9, s33
    v_add_u32 v9, 1, v9
    v_xor_b32 v9, v9, v6
    v_lshl_add_u32 v209, v9, 6, v8
    v_mov_b32 v64, 0
    v_mov_b32 v65, 0
    v_mov_b32 v66, 0
    v_mov_b32 v67, 0
    v_mov_b32 v68, 0
    v_mov_b32 v69, 0
    v_mov_b32 v70, 0
    v_mov_b32 v71, 0
    v_mov_b32 v72, 0
    v_mov_b32 v73, 0
    v_mov_b32 v74, 0
    v_mov_b32 v75, 0
    v_mov_b32 v76, 0
    v_mov_b32 v77, 0
    v_mov_b32 v78, 0
    v_mov_b32 v79, 0
    v_mov_b32 v80, 0
    v_mov_b32 v81, 0
    v_mov_b32 v82, 0
    v_mov_b32 v83, 0
    v_mov_b32 v84, 0
    v_mov_b32 v85, 0
    v_mov_b32 v86, 0
    v_mov_b32 v87, 0
    v_mov_b32 v88, 0
    v_mov_b32 v89, 0
    v_mov_b32 v90, 0
    v_mov_b32 v91, 0
    v_mov_b32 v92, 0
    v_mov_b32 v93, 0
    v_mov_b32 v94, 0
    v_mov_b32 v95, 0
    v_mov_b32 v96, 0
    v_mov_b32 v97, 0
    v_mov_b32 v98, 0
    v_mov_b32 v99, 0
    v_mov_b32 v100, 0
    v_mov_b32 v101, 0
    v_mov_b32 v102, 0
    v_mov_b32 v103, 0
    v_mov_b32 v104, 0
    v_mov_b32 v105, 0
    v_mov_b32 v106, 0
    v_mov_b32 v107, 0
    v_mov_b32 v108, 0
    v_mov_b32 v109, 0
    v_mov_b32 v110, 0
    v_mov_b32 v111, 0
    v_mov_b32 v112, 0
    v_mov_b32 v113, 0
    v_mov_b32 v114, 0
    v_mov_b32 v115, 0
    v_mov_b32 v116, 0
    v_mov_b32 v117, 0
    v_mov_b32 v118, 0
    v_mov_b32 v119, 0
    v_mov_b32 v120, 0
    v_mov_b32 v121, 0
    v_mov_b32 v122, 0
    v_mov_b32 v123, 0
    v_mov_b32 v124, 0
    v_mov_b32 v125, 0
    v_mov_b32 v126, 0
    v_mov_b32 v127, 0
    s_lshl_b32 s38, s28, 12
    s_lshl_b32 s39, s28, 11
    s_add_u32 s39, s39, 32768
    v_add_u32 v212, 49152, v204
    v_add_u32 v213, 49152, v205
    v_add_u32 v214, 49152, v206
    v_add_u32 v215, 49152, v207
    v_add_u32 v216, 49152, v208
    v_add_u32 v217, 49152, v209
    v_add_u32 v220, 98304, v204
    v_add_u32 v221, 98304, v205
    v_add_u32 v222, 98304, v206
    v_add_u32 v223, 98304, v207
    v_add_u32 v224, 98304, v208
    v_add_u32 v225, 98304, v209
    s_add_u32 m0, s38, 0
    s_movk_i32 s37, 0
    buffer_load_dwordx4 v200, s[12:15], s37 offen lds
    s_add_u32 m0, s38, 1024
    s_movk_i32 s37, 10240
    buffer_load_dwordx4 v201, s[12:15], s37 offen lds
    s_add_u32 m0, s38, 2048
    s_movk_i32 s37, 20480
    buffer_load_dwordx4 v200, s[12:15], s37 offen lds
    s_add_u32 m0, s38, 3072
    s_movk_i32 s37, 30720
    buffer_load_dwordx4 v201, s[12:15], s37 offen lds
    s_add_u32 m0, s39, 0
    s_mov_b32 s37, 0
    buffer_load_dwordx4 v203, s[16:19], s37 offen lds
    s_add_u32 m0, s39, 1024
    s_mov_b32 s37, 15360
    buffer_load_dwordx4 v203, s[16:19], s37 offen lds
    s_add_u32 m0, s38, 49152
    s_movk_i32 s37, 128
    buffer_load_dwordx4 v200, s[12:15], s37 offen lds
    s_add_u32 m0, s38, 50176
    s_movk_i32 s37, 10368
    buffer_load_dwordx4 v201, s[12:15], s37 offen lds
    s_add_u32 m0, s38, 51200
    s_movk_i32 s37, 20608
    buffer_load_dwordx4 v200, s[12:15], s37 offen lds
    s_add_u32 m0, s38, 52224
    s_movk_i32 s37, 30848
    buffer_load_dwordx4 v201, s[12:15], s37 offen lds
    s_add_u32 m0, s39, 49152
    s_mov_b32 s37, 245760
    buffer_load_dwordx4 v203, s[16:19], s37 offen lds
    s_add_u32 m0, s39, 50176
    s_mov_b32 s37, 261120
    buffer_load_dwordx4 v203, s[16:19], s37 offen lds
    s_waitcnt vmcnt(6)
    s_barrier
    s_cmp_ge_u32 s32, 10
    s_cbranch_scc1 K1_VLOOP
    ds_read_b128 v[128:131], v204 offset:0
    ds_read_b128 v[132:135], v204 offset:4096
    ds_read_b64_tr_b16 v[136:137], v208 offset:0
    ds_read_b64_tr_b16 v[138:139], v208 offset:1024
    ds_read_b64_tr_b16 v[140:141], v209 offset:0
    ds_read_b64_tr_b16 v[142:143], v209 offset:1024
    s_add_u32 m0, s38, 98304
    s_movk_i32 s37, 256
    buffer_load_dwordx4 v200, s[12:15], s37 offen lds
    s_add_u32 m0, s38, 99328
    s_movk_i32 s37, 10496
    buffer_load_dwordx4 v201, s[12:15], s37 offen lds
    s_add_u32 m0, s38, 100352
    s_movk_i32 s37, 20736
    buffer_load_dwordx4 v200, s[12:15], s37 offen lds
    s_add_u32 m0, s38, 101376
    s_movk_i32 s37, 30976
    buffer_load_dwordx4 v201, s[12:15], s37 offen lds
    s_add_u32 m0, s39, 98304
    s_mov_b32 s37, 491520
    buffer_load_dwordx4 v203, s[16:19], s37 offen lds
    s_add_u32 m0, s39, 99328
    s_mov_b32 s37, 506880
    buffer_load_dwordx4 v203, s[16:19], s37 offen lds
    s_waitcnt lgkmcnt(0)
    v_mfma_f32_32x32x16_bf16 v[64:79], v[136:139], v[128:131], v[64:79]
    ds_read_b128 v[144:147], v205 offset:0
    ds_read_b128 v[148:151], v205 offset:4096
    v_mfma_f32_32x32x16_bf16 v[80:95], v[140:143], v[128:131], v[80:95]
    ds_read_b64_tr_b16 v[152:153], v208 offset:4096
    ds_read_b64_tr_b16 v[154:155], v208 offset:5120
    v_mfma_f32_32x32x16_bf16 v[96:111], v[136:139], v[132:135], v[96:111]
    ds_read_b64_tr_b16 v[156:157], v209 offset:4096
    ds_read_b64_tr_b16 v[158:159], v209 offset:5120
    v_mfma_f32_32x32x16_bf16 v[112:127], v[140:143], v[132:135], v[112:127]
    s_waitcnt lgkmcnt(0)
    v_mfma_f32_32x32x16_bf16 v[64:79], v[152:155], v[144:147], v[64:79]
    ds_read_b128 v[128:131], v206 offset:0
    ds_read_b128 v[132:135], v206 offset:4096
    v_mfma_f32_32x32x16_bf16 v[80:95], v[156:159], v[144:147], v[80:95]
    ds_read_b64_tr_b16 v[136:137], v208 offset:8192
    ds_read_b64_tr_b16 v[138:139], v208 offset:9216
    v_mfma_f32_32x32x16_bf16 v[96:111], v[152:155], v[148:151], v[96:111]
    ds_read_b64_tr_b16 v[140:141], v209 offset:8192
    ds_read_b64_tr_b16 v[142:143], v209 offset:9216
    v_mfma_f32_32x32x16_bf16 v[112:127], v[156:159], v[148:151], v[112:127]
    s_waitcnt lgkmcnt(0)
    v_mfma_f32_32x32x16_bf16 v[64:79], v[136:139], v[128:131], v[64:79]
    ds_read_b128 v[144:147], v207 offset:0
    ds_read_b128 v[148:151], v207 offset:4096
    v_mfma_f32_32x32x16_bf16 v[80:95], v[140:143], v[128:131], v[80:95]
    ds_read_b64_tr_b16 v[152:153], v208 offset:12288
    ds_read_b64_tr_b16 v[154:155], v208 offset:13312
    v_mfma_f32_32x32x16_bf16 v[96:111], v[136:139], v[132:135], v[96:111]
    ds_read_b64_tr_b16 v[156:157], v209 offset:12288
    ds_read_b64_tr_b16 v[158:159], v209 offset:13312
    v_mfma_f32_32x32x16_bf16 v[112:127], v[140:143], v[132:135], v[112:127]
    s_waitcnt lgkmcnt(0)
    v_mfma_f32_32x32x16_bf16 v[64:79], v[152:155], v[144:147], v[64:79]
    v_mfma_f32_32x32x16_bf16 v[80:95], v[156:159], v[144:147], v[80:95]
    v_mfma_f32_32x32x16_bf16 v[96:111], v[152:155], v[148:151], v[96:111]
    v_mfma_f32_32x32x16_bf16 v[112:127], v[156:159], v[148:151], v[112:127]
    s_waitcnt vmcnt(6)
    s_barrier
    ds_read_b128 v[128:131], v212 offset:0
    ds_read_b128 v[132:135], v212 offset:4096
    ds_read_b64_tr_b16 v[136:137], v216 offset:0
    ds_read_b64_tr_b16 v[138:139], v216 offset:1024
    ds_read_b64_tr_b16 v[140:141], v217 offset:0
    ds_read_b64_tr_b16 v[142:143], v217 offset:1024
    s_add_u32 m0, s38, 0
    s_movk_i32 s37, 384
    buffer_load_dwordx4 v200, s[12:15], s37 offen lds
    s_add_u32 m0, s38, 1024
    s_movk_i32 s37, 10624
    buffer_load_dwordx4 v201, s[12:15], s37 offen lds
    s_add_u32 m0, s38, 2048
    s_movk_i32 s37, 20864
    buffer_load_dwordx4 v200, s[12:15], s37 offen lds
    s_add_u32 m0, s38, 3072
    s_movk_i32 s37, 31104
    buffer_load_dwordx4 v201, s[12:15], s37 offen lds
    s_add_u32 m0, s39, 0
    s_mov_b32 s37, 737280
    buffer_load_dwordx4 v203, s[16:19], s37 offen lds
    s_add_u32 m0, s39, 1024
    s_mov_b32 s37, 752640
    buffer_load_dwordx4 v203, s[16:19], s37 offen lds
    s_waitcnt lgkmcnt(0)
    v_mfma_f32_32x32x16_bf16 v[64:79], v[136:139], v[128:131], v[64:79]
    ds_read_b128 v[144:147], v213 offset:0
    ds_read_b128 v[148:151], v213 offset:4096
    v_mfma_f32_32x32x16_bf16 v[80:95], v[140:143], v[128:131], v[80:95]
    ds_read_b64_tr_b16 v[152:153], v216 offset:4096
    ds_read_b64_tr_b16 v[154:155], v216 offset:5120
    v_mfma_f32_32x32x16_bf16 v[96:111], v[136:139], v[132:135], v[96:111]
    ds_read_b64_tr_b16 v[156:157], v217 offset:4096
    ds_read_b64_tr_b16 v[158:159], v217 offset:5120
    v_mfma_f32_32x32x16_bf16 v[112:127], v[140:143], v[132:135], v[112:127]
    s_waitcnt lgkmcnt(0)
    v_mfma_f32_32x32x16_bf16 v[64:79], v[152:155], v[144:147], v[64:79]
    ds_read_b128 v[128:131], v214 offset:0
    ds_read_b128 v[132:135], v214 offset:4096
    v_mfma_f32_32x32x16_bf16 v[80:95], v[156:159], v[144:147], v[80:95]
    ds_read_b64_tr_b16 v[136:137], v216 offset:8192
    ds_read_b64_tr_b16 v[138:139], v216 offset:9216
    v_mfma_f32_32x32x16_bf16 v[96:111], v[152:155], v[148:151], v[96:111]
    ds_read_b64_tr_b16 v[140:141], v217 offset:8192
    ds_read_b64_tr_b16 v[142:143], v217 offset:9216
    v_mfma_f32_32x32x16_bf16 v[112:127], v[156:159], v[148:151], v[112:127]
    s_waitcnt lgkmcnt(0)
    v_mfma_f32_32x32x16_bf16 v[64:79], v[136:139], v[128:131], v[64:79]
    ds_read_b128 v[144:147], v215 offset:0
    ds_read_b128 v[148:151], v215 offset:4096
    v_mfma_f32_32x32x16_bf16 v[80:95], v[140:143], v[128:131], v[80:95]
    ds_read_b64_tr_b16 v[152:153], v216 offset:12288
    ds_read_b64_tr_b16 v[154:155], v216 offset:13312
    v_mfma_f32_32x32x16_bf16 v[96:111], v[136:139], v[132:135], v[96:111]
    ds_read_b64_tr_b16 v[156:157], v217 offset:12288
    ds_read_b64_tr_b16 v[158:159], v217 offset:13312
    v_mfma_f32_32x32x16_bf16 v[112:127], v[140:143], v[132:135], v[112:127]
    s_waitcnt lgkmcnt(0)
    v_mfma_f32_32x32x16_bf16 v[64:79], v[152:155], v[144:147], v[64:79]
    v_mfma_f32_32x32x16_bf16 v[80:95], v[156:159], v[144:147], v[80:95]
    v_mfma_f32_32x32x16_bf16 v[96:111], v[152:155], v[148:151], v[96:111]
    v_mfma_f32_32x32x16_bf16 v[112:127], v[156:159], v[148:151], v[112:127]
    s_waitcnt vmcnt(6)
    s_barrier
    ds_read_b128 v[128:131], v220 offset:0
    ds_read_b128 v[132:135], v220 offset:4096
    ds_read_b64_tr_b16 v[136:137], v224 offset:0
    ds_read_b64_tr_b16 v[138:139], v224 offset:1024
    ds_read_b64_tr_b16 v[140:141], v225 offset:0
    ds_read_b64_tr_b16 v[142:143], v225 offset:1024
    s_add_u32 m0, s38, 49152
    s_movk_i32 s37, 512
    buffer_load_dwordx4 v200, s[12:15], s37 offen lds
    s_add_u32 m0, s38, 50176
    s_movk_i32 s37, 10752
    buffer_load_dwordx4 v201, s[12:15], s37 offen lds
    s_add_u32 m0, s38, 51200
    s_movk_i32 s37, 20992
    buffer_load_dwordx4 v200, s[12:15], s37 offen lds
    s_add_u32 m0, s38, 52224
    s_movk_i32 s37, 31232
    buffer_load_dwordx4 v201, s[12:15], s37 offen lds
    s_add_u32 m0, s39, 49152
    s_mov_b32 s37, 983040
    buffer_load_dwordx4 v203, s[16:19], s37 offen lds
    s_add_u32 m0, s39, 50176
    s_mov_b32 s37, 998400
    buffer_load_dwordx4 v203, s[16:19], s37 offen lds
    s_waitcnt lgkmcnt(0)
    v_mfma_f32_32x32x16_bf16 v[64:79], v[136:139], v[128:131], v[64:79]
    ds_read_b128 v[144:147], v221 offset:0
    ds_read_b128 v[148:151], v221 offset:4096
    v_mfma_f32_32x32x16_bf16 v[80:95], v[140:143], v[128:131], v[80:95]
    ds_read_b64_tr_b16 v[152:153], v224 offset:4096
    ds_read_b64_tr_b16 v[154:155], v224 offset:5120
    v_mfma_f32_32x32x16_bf16 v[96:111], v[136:139], v[132:135], v[96:111]
    ds_read_b64_tr_b16 v[156:157], v225 offset:4096
    ds_read_b64_tr_b16 v[158:159], v225 offset:5120
    v_mfma_f32_32x32x16_bf16 v[112:127], v[140:143], v[132:135], v[112:127]
    s_waitcnt lgkmcnt(0)
    v_mfma_f32_32x32x16_bf16 v[64:79], v[152:155], v[144:147], v[64:79]
    ds_read_b128 v[128:131], v222 offset:0
    ds_read_b128 v[132:135], v222 offset:4096
    v_mfma_f32_32x32x16_bf16 v[80:95], v[156:159], v[144:147], v[80:95]
    ds_read_b64_tr_b16 v[136:137], v224 offset:8192
    ds_read_b64_tr_b16 v[138:139], v224 offset:9216
    v_mfma_f32_32x32x16_bf16 v[96:111], v[152:155], v[148:151], v[96:111]
    ds_read_b64_tr_b16 v[140:141], v225 offset:8192
    ds_read_b64_tr_b16 v[142:143], v225 offset:9216
    v_mfma_f32_32x32x16_bf16 v[112:127], v[156:159], v[148:151], v[112:127]
    s_waitcnt lgkmcnt(0)
    v_mfma_f32_32x32x16_bf16 v[64:79], v[136:139], v[128:131], v[64:79]
    ds_read_b128 v[144:147], v223 offset:0
    ds_read_b128 v[148:151], v223 offset:4096
    v_mfma_f32_32x32x16_bf16 v[80:95], v[140:143], v[128:131], v[80:95]
    ds_read_b64_tr_b16 v[152:153], v224 offset:12288
    ds_read_b64_tr_b16 v[154:155], v224 offset:13312
    v_mfma_f32_32x32x16_bf16 v[96:111], v[136:139], v[132:135], v[96:111]
    ds_read_b64_tr_b16 v[156:157], v225 offset:12288
    ds_read_b64_tr_b16 v[158:159], v225 offset:13312
    v_mfma_f32_32x32x16_bf16 v[112:127], v[140:143], v[132:135], v[112:127]
    s_waitcnt lgkmcnt(0)
    v_mfma_f32_32x32x16_bf16 v[64:79], v[152:155], v[144:147], v[64:79]
    v_mfma_f32_32x32x16_bf16 v[80:95], v[156:159], v[144:147], v[80:95]
    v_mfma_f32_32x32x16_bf16 v[96:111], v[152:155], v[148:151], v[96:111]
    v_mfma_f32_32x32x16_bf16 v[112:127], v[156:159], v[148:151], v[112:127]
    s_waitcnt vmcnt(6)
    s_barrier
    ds_read_b128 v[128:131], v204 offset:0
    ds_read_b128 v[132:135], v204 offset:4096
    ds_read_b64_tr_b16 v[136:137], v208 offset:0
    ds_read_b64_tr_b16 v[138:139], v208 offset:1024
    ds_read_b64_tr_b16 v[140:141], v209 offset:0
    ds_read_b64_tr_b16 v[142:143], v209 offset:1024
    s_add_u32 m0, s38, 98304
    s_movk_i32 s37, 640
    buffer_load_dwordx4 v200, s[12:15], s37 offen lds
    s_add_u32 m0, s38, 99328
    s_movk_i32 s37, 10880
    buffer_load_dwordx4 v201, s[12:15], s37 offen lds
    s_add_u32 m0, s38, 100352
    s_movk_i32 s37, 21120
    buffer_load_dwordx4 v200, s[12:15], s37 offen lds
    s_add_u32 m0, s38, 101376
    s_movk_i32 s37, 31360
    buffer_load_dwordx4 v201, s[12:15], s37 offen lds
    s_add_u32 m0, s39, 98304
    s_mov_b32 s37, 1228800
    buffer_load_dwordx4 v203, s[16:19], s37 offen lds
    s_add_u32 m0, s39, 99328
    s_mov_b32 s37, 1244160
    buffer_load_dwordx4 v203, s[16:19], s37 offen lds
    s_waitcnt lgkmcnt(0)
    v_mfma_f32_32x32x16_bf16 v[64:79], v[136:139], v[128:131], v[64:79]
    ds_read_b128 v[144:147], v205 offset:0
    ds_read_b128 v[148:151], v205 offset:4096
    v_mfma_f32_32x32x16_bf16 v[80:95], v[140:143], v[128:131], v[80:95]
    ds_read_b64_tr_b16 v[152:153], v208 offset:4096
    ds_read_b64_tr_b16 v[154:155], v208 offset:5120
    v_mfma_f32_32x32x16_bf16 v[96:111], v[136:139], v[132:135], v[96:111]
    ds_read_b64_tr_b16 v[156:157], v209 offset:4096
    ds_read_b64_tr_b16 v[158:159], v209 offset:5120
    v_mfma_f32_32x32x16_bf16 v[112:127], v[140:143], v[132:135], v[112:127]
    s_waitcnt lgkmcnt(0)
    v_mfma_f32_32x32x16_bf16 v[64:79], v[152:155], v[144:147], v[64:79]
    ds_read_b128 v[128:131], v206 offset:0
    ds_read_b128 v[132:135], v206 offset:4096
    v_mfma_f32_32x32x16_bf16 v[80:95], v[156:159], v[144:147], v[80:95]
    ds_read_b64_tr_b16 v[136:137], v208 offset:8192
    ds_read_b64_tr_b16 v[138:139], v208 offset:9216
    v_mfma_f32_32x32x16_bf16 v[96:111], v[152:155], v[148:151], v[96:111]
    ds_read_b64_tr_b16 v[140:141], v209 offset:8192
    ds_read_b64_tr_b16 v[142:143], v209 offset:9216
    v_mfma_f32_32x32x16_bf16 v[112:127], v[156:159], v[148:151], v[112:127]
    s_waitcnt lgkmcnt(0)
    v_mfma_f32_32x32x16_bf16 v[64:79], v[136:139], v[128:131], v[64:79]
    ds_read_b128 v[144:147], v207 offset:0
    ds_read_b128 v[148:151], v207 offset:4096
    v_mfma_f32_32x32x16_bf16 v[80:95], v[140:143], v[128:131], v[80:95]
    ds_read_b64_tr_b16 v[152:153], v208 offset:12288
    ds_read_b64_tr_b16 v[154:155], v208 offset:13312
    v_mfma_f32_32x32x16_bf16 v[96:111], v[136:139], v[132:135], v[96:111]
    ds_read_b64_tr_b16 v[156:157], v209 offset:12288
    ds_read_b64_tr_b16 v[158:159], v209 offset:13312
    v_mfma_f32_32x32x16_bf16 v[112:127], v[140:143], v[132:135], v[112:127]
    s_waitcnt lgkmcnt(0)
    v_mfma_f32_32x32x16_bf16 v[64:79], v[152:155], v[144:147], v[64:79]
    v_mfma_f32_32x32x16_bf16 v[80:95], v[156:159], v[144:147], v[80:95]
    v_mfma_f32_32x32x16_bf16 v[96:111], v[152:155], v[148:151], v[96:111]
    v_mfma_f32_32x32x16_bf16 v[112:127], v[156:159], v[148:151], v[112:127]
    s_waitcnt vmcnt(6)
    s_barrier
    ds_read_b128 v[128:131], v212 offset:0
    ds_read_b128 v[132:135], v212 offset:4096
    ds_read_b64_tr_b16 v[136:137], v216 offset:0
    ds_read_b64_tr_b16 v[138:139], v216 offset:1024
    ds_read_b64_tr_b16 v[140:141], v217 offset:0
    ds_read_b64_tr_b16 v[142:143], v217 offset:1024
    s_add_u32 m0, s38, 0
    s_movk_i32 s37, 768
    buffer_load_dwordx4 v200, s[12:15], s37 offen lds
    s_add_u32 m0, s38, 1024
    s_movk_i32 s37, 11008
    buffer_load_dwordx4 v201, s[12:15], s37 offen lds
    s_add_u32 m0, s38, 2048
    s_movk_i32 s37, 21248
    buffer_load_dwordx4 v200, s[12:15], s37 offen lds
    s_add_u32 m0, s38, 3072
    s_movk_i32 s37, 31488
    buffer_load_dwordx4 v201, s[12:15], s37 offen lds
    s_add_u32 m0, s39, 0
    s_mov_b32 s37, 1474560
    buffer_load_dwordx4 v203, s[16:19], s37 offen lds
    s_add_u32 m0, s39, 1024
    s_mov_b32 s37, 1489920
    buffer_load_dwordx4 v203, s[16:19], s37 offen lds
    s_waitcnt lgkmcnt(0)
    v_mfma_f32_32x32x16_bf16 v[64:79], v[136:139], v[128:131], v[64:79]
    ds_read_b128 v[144:147], v213 offset:0
    ds_read_b128 v[148:151], v213 offset:4096
    v_mfma_f32_32x32x16_bf16 v[80:95], v[140:143], v[128:131], v[80:95]
    ds_read_b64_tr_b16 v[152:153], v216 offset:4096
    ds_read_b64_tr_b16 v[154:155], v216 offset:5120
    v_mfma_f32_32x32x16_bf16 v[96:111], v[136:139], v[132:135], v[96:111]
    ds_read_b64_tr_b16 v[156:157], v217 offset:4096
    ds_read_b64_tr_b16 v[158:159], v217 offset:5120
    v_mfma_f32_32x32x16_bf16 v[112:127], v[140:143], v[132:135], v[112:127]
    s_waitcnt lgkmcnt(0)
    v_mfma_f32_32x32x16_bf16 v[64:79], v[152:155], v[144:147], v[64:79]
    ds_read_b128 v[128:131], v214 offset:0
    ds_read_b128 v[132:135], v214 offset:4096
    v_mfma_f32_32x32x16_bf16 v[80:95], v[156:159], v[144:147], v[80:95]
    ds_read_b64_tr_b16 v[136:137], v216 offset:8192
    ds_read_b64_tr_b16 v[138:139], v216 offset:9216
    v_mfma_f32_32x32x16_bf16 v[96:111], v[152:155], v[148:151], v[96:111]
    ds_read_b64_tr_b16 v[140:141], v217 offset:8192
    ds_read_b64_tr_b16 v[142:143], v217 offset:9216
    v_mfma_f32_32x32x16_bf16 v[112:127], v[156:159], v[148:151], v[112:127]
    s_waitcnt lgkmcnt(0)
    v_mfma_f32_32x32x16_bf16 v[64:79], v[136:139], v[128:131], v[64:79]
    ds_read_b128 v[144:147], v215 offset:0
    ds_read_b128 v[148:151], v215 offset:4096
    v_mfma_f32_32x32x16_bf16 v[80:95], v[140:143], v[128:131], v[80:95]
    ds_read_b64_tr_b16 v[152:153], v216 offset:12288
    ds_read_b64_tr_b16 v[154:155], v216 offset:13312
    v_mfma_f32_32x32x16_bf16 v[96:111], v[136:139], v[132:135], v[96:111]
    ds_read_b64_tr_b16 v[156:157], v217 offset:12288
    ds_read_b64_tr_b16 v[158:159], v217 offset:13312
    v_mfma_f32_32x32x16_bf16 v[112:127], v[140:143], v[132:135], v[112:127]
    s_waitcnt lgkmcnt(0)
    v_mfma_f32_32x32x16_bf16 v[64:79], v[152:155], v[144:147], v[64:79]
    v_mfma_f32_32x32x16_bf16 v[80:95], v[156:159], v[144:147], v[80:95]
    v_mfma_f32_32x32x16_bf16 v[96:111], v[152:155], v[148:151], v[96:111]
    v_mfma_f32_32x32x16_bf16 v[112:127], v[156:159], v[148:151], v[112:127]
    s_waitcnt vmcnt(6)
    s_barrier
    ds_read_b128 v[128:131], v220 offset:0
    ds_read_b128 v[132:135], v220 offset:4096
    ds_read_b64_tr_b16 v[136:137], v224 offset:0
    ds_read_b64_tr_b16 v[138:139], v224 offset:1024
    ds_read_b64_tr_b16 v[140:141], v225 offset:0
    ds_read_b64_tr_b16 v[142:143], v225 offset:1024
    s_add_u32 m0, s38, 49152
    s_movk_i32 s37, 896
    buffer_load_dwordx4 v200, s[12:15], s37 offen lds
    s_add_u32 m0, s38, 50176
    s_movk_i32 s37, 11136
    buffer_load_dwordx4 v201, s[12:15], s37 offen lds
    s_add_u32 m0, s38, 51200
    s_movk_i32 s37, 21376
    buffer_load_dwordx4 v200, s[12:15], s37 offen lds
    s_add_u32 m0, s38, 52224
    s_movk_i32 s37, 31616
    buffer_load_dwordx4 v201, s[12:15], s37 offen lds
    s_add_u32 m0, s39, 49152
    s_mov_b32 s37, 1720320
    buffer_load_dwordx4 v203, s[16:19], s37 offen lds
    s_add_u32 m0, s39, 50176
    s_mov_b32 s37, 1735680
    buffer_load_dwordx4 v203, s[16:19], s37 offen lds
    s_waitcnt lgkmcnt(0)
    v_mfma_f32_32x32x16_bf16 v[64:79], v[136:139], v[128:131], v[64:79]
    ds_read_b128 v[144:147], v221 offset:0
    ds_read_b128 v[148:151], v221 offset:4096
    v_mfma_f32_32x32x16_bf16 v[80:95], v[140:143], v[128:131], v[80:95]
    ds_read_b64_tr_b16 v[152:153], v224 offset:4096
    ds_read_b64_tr_b16 v[154:155], v224 offset:5120
    v_mfma_f32_32x32x16_bf16 v[96:111], v[136:139], v[132:135], v[96:111]
    ds_read_b64_tr_b16 v[156:157], v225 offset:4096
    ds_read_b64_tr_b16 v[158:159], v225 offset:5120
    v_mfma_f32_32x32x16_bf16 v[112:127], v[140:143], v[132:135], v[112:127]
    s_waitcnt lgkmcnt(0)
    v_mfma_f32_32x32x16_bf16 v[64:79], v[152:155], v[144:147], v[64:79]
    ds_read_b128 v[128:131], v222 offset:0
    ds_read_b128 v[132:135], v222 offset:4096
    v_mfma_f32_32x32x16_bf16 v[80:95], v[156:159], v[144:147], v[80:95]
    ds_read_b64_tr_b16 v[136:137], v224 offset:8192
    ds_read_b64_tr_b16 v[138:139], v224 offset:9216
    v_mfma_f32_32x32x16_bf16 v[96:111], v[152:155], v[148:151], v[96:111]
    ds_read_b64_tr_b16 v[140:141], v225 offset:8192
    ds_read_b64_tr_b16 v[142:143], v225 offset:9216
    v_mfma_f32_32x32x16_bf16 v[112:127], v[156:159], v[148:151], v[112:127]
    s_waitcnt lgkmcnt(0)
    v_mfma_f32_32x32x16_bf16 v[64:79], v[136:139], v[128:131], v[64:79]
    ds_read_b128 v[144:147], v223 offset:0
    ds_read_b128 v[148:151], v223 offset:4096
    v_mfma_f32_32x32x16_bf16 v[80:95], v[140:143], v[128:131], v[80:95]
    ds_read_b64_tr_b16 v[152:153], v224 offset:12288
    ds_read_b64_tr_b16 v[154:155], v224 offset:13312
    v_mfma_f32_32x32x16_bf16 v[96:111], v[136:139], v[132:135], v[96:111]
    ds_read_b64_tr_b16 v[156:157], v225 offset:12288
    ds_read_b64_tr_b16 v[158:159], v225 offset:13312
    v_mfma_f32_32x32x16_bf16 v[112:127], v[140:143], v[132:135], v[112:127]
    s_waitcnt lgkmcnt(0)
    v_mfma_f32_32x32x16_bf16 v[64:79], v[152:155], v[144:147], v[64:79]
    v_mfma_f32_32x32x16_bf16 v[80:95], v[156:159], v[144:147], v[80:95]
    v_mfma_f32_32x32x16_bf16 v[96:111], v[152:155], v[148:151], v[96:111]
    v_mfma_f32_32x32x16_bf16 v[112:127], v[156:159], v[148:151], v[112:127]
    s_waitcnt vmcnt(6)
    s_barrier
    ds_read_b128 v[128:131], v204 offset:0
    ds_read_b128 v[132:135], v204 offset:4096
    ds_read_b64_tr_b16 v[136:137], v208 offset:0
    ds_read_b64_tr_b16 v[138:139], v208 offset:1024
    ds_read_b64_tr_b16 v[140:141], v209 offset:0
    ds_read_b64_tr_b16 v[142:143], v209 offset:1024
    s_add_u32 m0, s38, 98304
    s_movk_i32 s37, 1024
    buffer_load_dwordx4 v200, s[12:15], s37 offen lds
    s_add_u32 m0, s38, 99328
    s_movk_i32 s37, 11264
    buffer_load_dwordx4 v201, s[12:15], s37 offen lds
    s_add_u32 m0, s38, 100352
    s_movk_i32 s37, 21504
    buffer_load_dwordx4 v200, s[12:15], s37 offen lds
    s_add_u32 m0, s38, 101376
    s_movk_i32 s37, 31744
    buffer_load_dwordx4 v201, s[12:15], s37 offen lds
    s_add_u32 m0, s39, 98304
    s_mov_b32 s37, 1966080
    buffer_load_dwordx4 v203, s[16:19], s37 offen lds
    s_add_u32 m0, s39, 99328
    s_mov_b32 s37, 1981440
    buffer_load_dwordx4 v203, s[16:19], s37 offen lds
    s_waitcnt lgkmcnt(0)
    v_mfma_f32_32x32x16_bf16 v[64:79], v[136:139], v[128:131], v[64:79]
    ds_read_b128 v[144:147], v205 offset:0
    ds_read_b128 v[148:151], v205 offset:4096
    v_mfma_f32_32x32x16_bf16 v[80:95], v[140:143], v[128:131], v[80:95]
    ds_read_b64_tr_b16 v[152:153], v208 offset:4096
    ds_read_b64_tr_b16 v[154:155], v208 offset:5120
    v_mfma_f32_32x32x16_bf16 v[96:111], v[136:139], v[132:135], v[96:111]
    ds_read_b64_tr_b16 v[156:157], v209 offset:4096
    ds_read_b64_tr_b16 v[158:159], v209 offset:5120
    v_mfma_f32_32x32x16_bf16 v[112:127], v[140:143], v[132:135], v[112:127]
    s_waitcnt lgkmcnt(0)
    v_mfma_f32_32x32x16_bf16 v[64:79], v[152:155], v[144:147], v[64:79]
    ds_read_b128 v[128:131], v206 offset:0
    ds_read_b128 v[132:135], v206 offset:4096
    v_mfma_f32_32x32x16_bf16 v[80:95], v[156:159], v[144:147], v[80:95]
    ds_read_b64_tr_b16 v[136:137], v208 offset:8192
    ds_read_b64_tr_b16 v[138:139], v208 offset:9216
    v_mfma_f32_32x32x16_bf16 v[96:111], v[152:155], v[148:151], v[96:111]
    ds_read_b64_tr_b16 v[140:141], v209 offset:8192
    ds_read_b64_tr_b16 v[142:143], v209 offset:9216
    v_mfma_f32_32x32x16_bf16 v[112:127], v[156:159], v[148:151], v[112:127]
    s_waitcnt lgkmcnt(0)
    v_mfma_f32_32x32x16_bf16 v[64:79], v[136:139], v[128:131], v[64:79]
    ds_read_b128 v[144:147], v207 offset:0
    ds_read_b128 v[148:151], v207 offset:4096
    v_mfma_f32_32x32x16_bf16 v[80:95], v[140:143], v[128:131], v[80:95]
    ds_read_b64_tr_b16 v[152:153], v208 offset:12288
    ds_read_b64_tr_b16 v[154:155], v208 offset:13312
    v_mfma_f32_32x32x16_bf16 v[96:111], v[136:139], v[132:135], v[96:111]
    ds_read_b64_tr_b16 v[156:157], v209 offset:12288
    ds_read_b64_tr_b16 v[158:159], v209 offset:13312
    v_mfma_f32_32x32x16_bf16 v[112:127], v[140:143], v[132:135], v[112:127]
    s_waitcnt lgkmcnt(0)
    v_mfma_f32_32x32x16_bf16 v[64:79], v[152:155], v[144:147], v[64:79]
    v_mfma_f32_32x32x16_bf16 v[80:95], v[156:159], v[144:147], v[80:95]
    v_mfma_f32_32x32x16_bf16 v[96:111], v[152:155], v[148:151], v[96:111]
    v_mfma_f32_32x32x16_bf16 v[112:127], v[156:159], v[148:151], v[112:127]
    s_waitcnt vmcnt(6)
    s_barrier
    ds_read_b128 v[128:131], v212 offset:0
    ds_read_b128 v[132:135], v212 offset:4096
    ds_read_b64_tr_b16 v[136:137], v216 offset:0
    ds_read_b64_tr_b16 v[138:139], v216 offset:1024
    ds_read_b64_tr_b16 v[140:141], v217 offset:0
    ds_read_b64_tr_b16 v[142:143], v217 offset:1024
    s_add_u32 m0, s38, 0
    s_movk_i32 s37, 1152
    buffer_load_dwordx4 v200, s[12:15], s37 offen lds
    s_add_u32 m0, s38, 1024
    s_movk_i32 s37, 11392
    buffer_load_dwordx4 v201, s[12:15], s37 offen lds
    s_add_u32 m0, s38, 2048
    s_movk_i32 s37, 21632
    buffer_load_dwordx4 v200, s[12:15], s37 offen lds
    s_add_u32 m0, s38, 3072
    s_movk_i32 s37, 31872
    buffer_load_dwordx4 v201, s[12:15], s37 offen lds
    s_add_u32 m0, s39, 0
    s_mov_b32 s37, 2211840
    buffer_load_dwordx4 v203, s[16:19], s37 offen lds
    s_add_u32 m0, s39, 1024
    s_mov_b32 s37, 2227200
    buffer_load_dwordx4 v203, s[16:19], s37 offen lds
    s_waitcnt lgkmcnt(0)
    v_mfma_f32_32x32x16_bf16 v[64:79], v[136:139], v[128:131], v[64:79]
    ds_read_b128 v[144:147], v213 offset:0
    ds_read_b128 v[148:151], v213 offset:4096
    v_mfma_f32_32x32x16_bf16 v[80:95], v[140:143], v[128:131], v[80:95]
    ds_read_b64_tr_b16 v[152:153], v216 offset:4096
    ds_read_b64_tr_b16 v[154:155], v216 offset:5120
    v_mfma_f32_32x32x16_bf16 v[96:111], v[136:139], v[132:135], v[96:111]
    ds_read_b64_tr_b16 v[156:157], v217 offset:4096
    ds_read_b64_tr_b16 v[158:159], v217 offset:5120
    v_mfma_f32_32x32x16_bf16 v[112:127], v[140:143], v[132:135], v[112:127]
    s_waitcnt lgkmcnt(0)
    v_mfma_f32_32x32x16_bf16 v[64:79], v[152:155], v[144:147], v[64:79]
    ds_read_b128 v[128:131], v214 offset:0
    ds_read_b128 v[132:135], v214 offset:4096
    v_mfma_f32_32x32x16_bf16 v[80:95], v[156:159], v[144:147], v[80:95]
    ds_read_b64_tr_b16 v[136:137], v216 offset:8192
    ds_read_b64_tr_b16 v[138:139], v216 offset:9216
    v_mfma_f32_32x32x16_bf16 v[96:111], v[152:155], v[148:151], v[96:111]
    ds_read_b64_tr_b16 v[140:141], v217 offset:8192
    ds_read_b64_tr_b16 v[142:143], v217 offset:9216
    v_mfma_f32_32x32x16_bf16 v[112:127], v[156:159], v[148:151], v[112:127]
    s_waitcnt lgkmcnt(0)
    v_mfma_f32_32x32x16_bf16 v[64:79], v[136:139], v[128:131], v[64:79]
    ds_read_b128 v[144:147], v215 offset:0
    ds_read_b128 v[148:151], v215 offset:4096
    v_mfma_f32_32x32x16_bf16 v[80:95], v[140:143], v[128:131], v[80:95]
    ds_read_b64_tr_b16 v[152:153], v216 offset:12288
    ds_read_b64_tr_b16 v[154:155], v216 offset:13312
    v_mfma_f32_32x32x16_bf16 v[96:111], v[136:139], v[132:135], v[96:111]
    ds_read_b64_tr_b16 v[156:157], v217 offset:12288
    ds_read_b64_tr_b16 v[158:159], v217 offset:13312
    v_mfma_f32_32x32x16_bf16 v[112:127], v[140:143], v[132:135], v[112:127]
    s_waitcnt lgkmcnt(0)
    v_mfma_f32_32x32x16_bf16 v[64:79], v[152:155], v[144:147], v[64:79]
    v_mfma_f32_32x32x16_bf16 v[80:95], v[156:159], v[144:147], v[80:95]
    v_mfma_f32_32x32x16_bf16 v[96:111], v[152:155], v[148:151], v[96:111]
    v_mfma_f32_32x32x16_bf16 v[112:127], v[156:159], v[148:151], v[112:127]
    s_waitcnt vmcnt(6)
    s_barrier
    ds_read_b128 v[128:131], v220 offset:0
    ds_read_b128 v[132:135], v220 offset:4096
    ds_read_b64_tr_b16 v[136:137], v224 offset:0
    ds_read_b64_tr_b16 v[138:139], v224 offset:1024
    ds_read_b64_tr_b16 v[140:141], v225 offset:0
    ds_read_b64_tr_b16 v[142:143], v225 offset:1024
    s_waitcnt lgkmcnt(0)
    v_mfma_f32_32x32x16_bf16 v[64:79], v[136:139], v[128:131], v[64:79]
    ds_read_b128 v[144:147], v221 offset:0
    ds_read_b128 v[148:151], v221 offset:4096
    v_mfma_f32_32x32x16_bf16 v[80:95], v[140:143], v[128:131], v[80:95]
    ds_read_b64_tr_b16 v[152:153], v224 offset:4096
    ds_read_b64_tr_b16 v[154:155], v224 offset:5120
    v_mfma_f32_32x32x16_bf16 v[96:111], v[136:139], v[132:135], v[96:111]
    ds_read_b64_tr_b16 v[156:157], v225 offset:4096
    ds_read_b64_tr_b16 v[158:159], v225 offset:5120
    v_mfma_f32_32x32x16_bf16 v[112:127], v[140:143], v[132:135], v[112:127]
    s_waitcnt lgkmcnt(0)
    v_mfma_f32_32x32x16_bf16 v[64:79], v[152:155], v[144:147], v[64:79]
    ds_read_b128 v[128:131], v222 offset:0
    ds_read_b128 v[132:135], v222 offset:4096
    v_mfma_f32_32x32x16_bf16 v[80:95], v[156:159], v[144:147], v[80:95]
    ds_read_b64_tr_b16 v[136:137], v224 offset:8192
    ds_read_b64_tr_b16 v[138:139], v224 offset:9216
    v_mfma_f32_32x32x16_bf16 v[96:111], v[152:155], v[148:151], v[96:111]
    ds_read_b64_tr_b16 v[140:141], v225 offset:8192
    ds_read_b64_tr_b16 v[142:143], v225 offset:9216
    v_mfma_f32_32x32x16_bf16 v[112:127], v[156:159], v[148:151], v[112:127]
    s_waitcnt lgkmcnt(0)
    v_mfma_f32_32x32x16_bf16 v[64:79], v[136:139], v[128:131], v[64:79]
    ds_read_b128 v[144:147], v223 offset:0
    ds_read_b128 v[148:151], v223 offset:4096
    v_mfma_f32_32x32x16_bf16 v[80:95], v[140:143], v[128:131], v[80:95]
    ds_read_b64_tr_b16 v[152:153], v224 offset:12288
    ds_read_b64_tr_b16 v[154:155], v224 offset:13312
    v_mfma_f32_32x32x16_bf16 v[96:111], v[136:139], v[132:135], v[96:111]
    ds_read_b64_tr_b16 v[156:157], v225 offset:12288
    ds_read_b64_tr_b16 v[158:159], v225 offset:13312
    v_mfma_f32_32x32x16_bf16 v[112:127], v[140:143], v[132:135], v[112:127]
    s_waitcnt lgkmcnt(0)
    v_mfma_f32_32x32x16_bf16 v[64:79], v[152:155], v[144:147], v[64:79]
    v_mfma_f32_32x32x16_bf16 v[80:95], v[156:159], v[144:147], v[80:95]
    v_mfma_f32_32x32x16_bf16 v[96:111], v[152:155], v[148:151], v[96:111]
    v_mfma_f32_32x32x16_bf16 v[112:127], v[156:159], v[148:151], v[112:127]
    s_waitcnt vmcnt(0)
    s_barrier
    ds_read_b128 v[128:131], v204 offset:0
    ds_read_b128 v[132:135], v204 offset:4096
    ds_read_b64_tr_b16 v[136:137], v208 offset:0
    ds_read_b64_tr_b16 v[138:139], v208 offset:1024
    ds_read_b64_tr_b16 v[140:141], v209 offset:0
    ds_read_b64_tr_b16 v[142:143], v209 offset:1024
    s_waitcnt lgkmcnt(0)
    v_mfma_f32_32x32x16_bf16 v[64:79], v[136:139], v[128:131], v[64:79]
    ds_read_b128 v[144:147], v205 offset:0
    ds_read_b128 v[148:151], v205 offset:4096
    v_mfma_f32_32x32x16_bf16 v[80:95], v[140:143], v[128:131], v[80:95]
    ds_read_b64_tr_b16 v[152:153], v208 offset:4096
    ds_read_b64_tr_b16 v[154:155], v208 offset:5120
    v_mfma_f32_32x32x16_bf16 v[96:111], v[136:139], v[132:135], v[96:111]
    ds_read_b64_tr_b16 v[156:157], v209 offset:4096
    ds_read_b64_tr_b16 v[158:159], v209 offset:5120
    v_mfma_f32_32x32x16_bf16 v[112:127], v[140:143], v[132:135], v[112:127]
    s_waitcnt lgkmcnt(0)
    v_mfma_f32_32x32x16_bf16 v[64:79], v[152:155], v[144:147], v[64:79]
    ds_read_b128 v[128:131], v206 offset:0
    ds_read_b128 v[132:135], v206 offset:4096
    v_mfma_f32_32x32x16_bf16 v[80:95], v[156:159], v[144:147], v[80:95]
    ds_read_b64_tr_b16 v[136:137], v208 offset:8192
    ds_read_b64_tr_b16 v[138:139], v208 offset:9216
    v_mfma_f32_32x32x16_bf16 v[96:111], v[152:155], v[148:151], v[96:111]
    ds_read_b64_tr_b16 v[140:141], v209 offset:8192
    ds_read_b64_tr_b16 v[142:143], v209 offset:9216
    v_mfma_f32_32x32x16_bf16 v[112:127], v[156:159], v[148:151], v[112:127]
    s_waitcnt lgkmcnt(0)
    v_mfma_f32_32x32x16_bf16 v[64:79], v[136:139], v[128:131], v[64:79]
    ds_read_b128 v[144:147], v207 offset:0
    ds_read_b128 v[148:151], v207 offset:4096
    v_mfma_f32_32x32x16_bf16 v[80:95], v[140:143], v[128:131], v[80:95]
    ds_read_b64_tr_b16 v[152:153], v208 offset:12288
    ds_read_b64_tr_b16 v[154:155], v208 offset:13312
    v_mfma_f32_32x32x16_bf16 v[96:111], v[136:139], v[132:135], v[96:111]
    ds_read_b64_tr_b16 v[156:157], v209 offset:12288
    ds_read_b64_tr_b16 v[158:159], v209 offset:13312
    v_mfma_f32_32x32x16_bf16 v[112:127], v[140:143], v[132:135], v[112:127]
    s_waitcnt lgkmcnt(0)
    v_mfma_f32_32x32x16_bf16 v[64:79], v[152:155], v[144:147], v[64:79]
    v_mfma_f32_32x32x16_bf16 v[80:95], v[156:159], v[144:147], v[80:95]
    v_mfma_f32_32x32x16_bf16 v[96:111], v[152:155], v[148:151], v[96:111]
    v_mfma_f32_32x32x16_bf16 v[112:127], v[156:159], v[148:151], v[112:127]
    s_nop 15
    s_nop 3
    v_and_b32 v3, 31, v1
    v_lshrrev_b32 v4, 5, v1
    s_cmp_lt_u32 s32, 5
    s_cselect_b32 s40, 1, 0
    s_sub_u32 s41, s32, 5
    s_cmp_lt_u32 s32, 5
    s_cselect_b32 s41, s32, s41
    s_movk_i32 s42, 3072
    s_mov_b32 s43, 0x0
    s_mov_b32 s44, 0xc00000
    s_cmp_eq_u32 s40, 1
    s_cbranch_scc0 K1_QKISK
    s_movk_i32 s42, 1024
    s_mov_b32 s43, 0xd00000
    s_mov_b32 s44, 0x1100000
    s_mov_b32 s47, 0x3ea52b5c
    v_mul_f32 v64, s47, v64
    v_mul_f32 v65, s47, v65
    v_mul_f32 v66, s47, v66
    v_mul_f32 v67, s47, v67
    v_mul_f32 v68, s47, v68
    v_mul_f32 v69, s47, v69
    v_mul_f32 v70, s47, v70
    v_mul_f32 v71, s47, v71
    v_mul_f32 v72, s47, v72
    v_mul_f32 v73, s47, v73
    v_mul_f32 v74, s47, v74
    v_mul_f32 v75, s47, v75
    v_mul_f32 v76, s47, v76
    v_mul_f32 v77, s47, v77
    v_mul_f32 v78, s47, v78
    v_mul_f32 v79, s47, v79
    v_mul_f32 v80, s47, v80
    v_mul_f32 v81, s47, v81
    v_mul_f32 v82, s47, v82
    v_mul_f32 v83, s47, v83
    v_mul_f32 v84, s47, v84
    v_mul_f32 v85, s47, v85
    v_mul_f32 v86, s47, v86
    v_mul_f32 v87, s47, v87
    v_mul_f32 v88, s47, v88
    v_mul_f32 v89, s47, v89
    v_mul_f32 v90, s47, v90
    v_mul_f32 v91, s47, v91
    v_mul_f32 v92, s47, v92
    v_mul_f32 v93, s47, v93
    v_mul_f32 v94, s47, v94
    v_mul_f32 v95, s47, v95
    v_mul_f32 v96, s47, v96
    v_mul_f32 v97, s47, v97
    v_mul_f32 v98, s47, v98
    v_mul_f32 v99, s47, v99
    v_mul_f32 v100, s47, v100
    v_mul_f32 v101, s47, v101
    v_mul_f32 v102, s47, v102
    v_mul_f32 v103, s47, v103
    v_mul_f32 v104, s47, v104
    v_mul_f32 v105, s47, v105
    v_mul_f32 v106, s47, v106
    v_mul_f32 v107, s47, v107
    v_mul_f32 v108, s47, v108
    v_mul_f32 v109, s47, v109
    v_mul_f32 v110, s47, v110
    v_mul_f32 v111, s47, v111
    v_mul_f32 v112, s47, v112
    v_mul_f32 v113, s47, v113
    v_mul_f32 v114, s47, v114
    v_mul_f32 v115, s47, v115
    v_mul_f32 v116, s47, v116
    v_mul_f32 v117, s47, v117
    v_mul_f32 v118, s47, v118
    v_mul_f32 v119, s47, v119
    v_mul_f32 v120, s47, v120
    v_mul_f32 v121, s47, v121
    v_mul_f32 v122, s47, v122
    v_mul_f32 v123, s47, v123
    v_mul_f32 v124, s47, v124
    v_mul_f32 v125, s47, v125
    v_mul_f32 v126, s47, v126
    v_mul_f32 v127, s47, v127
K1_QKISK:
    s_lshl_b32 s45, s31, 11
    s_lshl_b32 s46, s29, 3
    s_add_u32 s45, s45, s46
    s_lshl_b32 s46, s34, 1
    s_add_u32 s45, s45, s46
    s_lshl_b32 s46, s41, 5
    s_lshl_b32 s47, s35, 4
    s_add_u32 s46, s46, s47
    v_add_u32 v5, s46, v4
    v_add_u32 v6, 0, v5
    v_mul_u32_u24 v7, 13108, v6
    v_lshrrev_b32 v7, 16, v7
    v_mul_u32_u24 v8, 5, v7
    v_sub_u32 v8, v6, v8
    v_lshlrev_b32 v9, 6, v7
    v_add_u32 v9, s45, v9
    v_mul_lo_u32 v10, v9, s42
    v_add_u32 v10, s43, v10
    v_lshrrev_b32 v11, 1, v8
    v_lshl_add_u32 v11, v11, 5, v3
    v_lshl_add_u32 v10, v11, 4, v10
    v_and_b32 v11, 1, v8
    v_lshl_add_u32 v10, v11, 3, v10
    v_lshl_add_u32 v12, v9, 8, s44
    v_lshl_add_u32 v12, v3, 3, v12
    v_cmp_eq_u32 vcc, 4, v8
    v_mov_b32 v13, s42
    v_mov_b32 v14, 256
    v_cndmask_b32 v10, v10, v12, vcc
    v_cndmask_b32 v13, v13, v14, vcc
    v_add_u32 v13, v10, v13
    v_cvt_pk_bf16_f32 v16, v64, v65
    v_cvt_pk_bf16_f32 v17, v66, v67
    buffer_store_dwordx2 v[16:17], v10, s[20:23], 0 offen
    s_nop 0
    v_cvt_pk_bf16_f32 v16, v96, v97
    v_cvt_pk_bf16_f32 v17, v98, v99
    buffer_store_dwordx2 v[16:17], v13, s[20:23], 0 offen
    s_nop 0
    v_add_u32 v6, 2, v5
    v_mul_u32_u24 v7, 13108, v6
    v_lshrrev_b32 v7, 16, v7
    v_mul_u32_u24 v8, 5, v7
    v_sub_u32 v8, v6, v8
    v_lshlrev_b32 v9, 6, v7
    v_add_u32 v9, s45, v9
    v_mul_lo_u32 v10, v9, s42
    v_add_u32 v10, s43, v10
    v_lshrrev_b32 v11, 1, v8
    v_lshl_add_u32 v11, v11, 5, v3
    v_lshl_add_u32 v10, v11, 4, v10
    v_and_b32 v11, 1, v8
    v_lshl_add_u32 v10, v11, 3, v10
    v_lshl_add_u32 v12, v9, 8, s44
    v_lshl_add_u32 v12, v3, 3, v12
    v_cmp_eq_u32 vcc, 4, v8
    v_mov_b32 v13, s42
    v_mov_b32 v14, 256
    v_cndmask_b32 v10, v10, v12, vcc
    v_cndmask_b32 v13, v13, v14, vcc
    v_add_u32 v13, v10, v13
    v_cvt_pk_bf16_f32 v16, v68, v69
    v_cvt_pk_bf16_f32 v17, v70, v71
    buffer_store_dwordx2 v[16:17], v10, s[20:23], 0 offen
    s_nop 0
    v_cvt_pk_bf16_f32 v16, v100, v101
    v_cvt_pk_bf16_f32 v17, v102, v103
    buffer_store_dwordx2 v[16:17], v13, s[20:23], 0 offen
    s_nop 0
    v_add_u32 v6, 4, v5
    v_mul_u32_u24 v7, 13108, v6
    v_lshrrev_b32 v7, 16, v7
    v_mul_u32_u24 v8, 5, v7
    v_sub_u32 v8, v6, v8
    v_lshlrev_b32 v9, 6, v7
    v_add_u32 v9, s45, v9
    v_mul_lo_u32 v10, v9, s42
    v_add_u32 v10, s43, v10
    v_lshrrev_b32 v11, 1, v8
    v_lshl_add_u32 v11, v11, 5, v3
    v_lshl_add_u32 v10, v11, 4, v10
    v_and_b32 v11, 1, v8
    v_lshl_add_u32 v10, v11, 3, v10
    v_lshl_add_u32 v12, v9, 8, s44
    v_lshl_add_u32 v12, v3, 3, v12
    v_cmp_eq_u32 vcc, 4, v8
    v_mov_b32 v13, s42
    v_mov_b32 v14, 256
    v_cndmask_b32 v10, v10, v12, vcc
    v_cndmask_b32 v13, v13, v14, vcc
    v_add_u32 v13, v10, v13
    v_cvt_pk_bf16_f32 v16, v72, v73
    v_cvt_pk_bf16_f32 v17, v74, v75
    buffer_store_dwordx2 v[16:17], v10, s[20:23], 0 offen
    s_nop 0
    v_cvt_pk_bf16_f32 v16, v104, v105
    v_cvt_pk_bf16_f32 v17, v106, v107
    buffer_store_dwordx2 v[16:17], v13, s[20:23], 0 offen
    s_nop 0
    v_add_u32 v6, 6, v5
    v_mul_u32_u24 v7, 13108, v6
    v_lshrrev_b32 v7, 16, v7
    v_mul_u32_u24 v8, 5, v7
    v_sub_u32 v8, v6, v8
    v_lshlrev_b32 v9, 6, v7
    v_add_u32 v9, s45, v9
    v_mul_lo_u32 v10, v9, s42
    v_add_u32 v10, s43, v10
    v_lshrrev_b32 v11, 1, v8
    v_lshl_add_u32 v11, v11, 5, v3
    v_lshl_add_u32 v10, v11, 4, v10
    v_and_b32 v11, 1, v8
    v_lshl_add_u32 v10, v11, 3, v10
    v_lshl_add_u32 v12, v9, 8, s44
    v_lshl_add_u32 v12, v3, 3, v12
    v_cmp_eq_u32 vcc, 4, v8
    v_mov_b32 v13, s42
    v_mov_b32 v14, 256
    v_cndmask_b32 v10, v10, v12, vcc
    v_cndmask_b32 v13, v13, v14, vcc
    v_add_u32 v13, v10, v13
    v_cvt_pk_bf16_f32 v16, v76, v77
    v_cvt_pk_bf16_f32 v17, v78, v79
    buffer_store_dwordx2 v[16:17], v10, s[20:23], 0 offen
    s_nop 0
    v_cvt_pk_bf16_f32 v16, v108, v109
    v_cvt_pk_bf16_f32 v17, v110, v111
    buffer_store_dwordx2 v[16:17], v13, s[20:23], 0 offen
    s_nop 0
    v_add_u32 v6, 8, v5
    v_mul_u32_u24 v7, 13108, v6
    v_lshrrev_b32 v7, 16, v7
    v_mul_u32_u24 v8, 5, v7
    v_sub_u32 v8, v6, v8
    v_lshlrev_b32 v9, 6, v7
    v_add_u32 v9, s45, v9
    v_mul_lo_u32 v10, v9, s42
    v_add_u32 v10, s43, v10
    v_lshrrev_b32 v11, 1, v8
    v_lshl_add_u32 v11, v11, 5, v3
    v_lshl_add_u32 v10, v11, 4, v10
    v_and_b32 v11, 1, v8
    v_lshl_add_u32 v10, v11, 3, v10
    v_lshl_add_u32 v12, v9, 8, s44
    v_lshl_add_u32 v12, v3, 3, v12
    v_cmp_eq_u32 vcc, 4, v8
    v_mov_b32 v13, s42
    v_mov_b32 v14, 256
    v_cndmask_b32 v10, v10, v12, vcc
    v_cndmask_b32 v13, v13, v14, vcc
    v_add_u32 v13, v10, v13
    v_cvt_pk_bf16_f32 v16, v80, v81
    v_cvt_pk_bf16_f32 v17, v82, v83
    buffer_store_dwordx2 v[16:17], v10, s[20:23], 0 offen
    s_nop 0
    v_cvt_pk_bf16_f32 v16, v112, v113
    v_cvt_pk_bf16_f32 v17, v114, v115
    buffer_store_dwordx2 v[16:17], v13, s[20:23], 0 offen
    s_nop 0
    v_add_u32 v6, 10, v5
    v_mul_u32_u24 v7, 13108, v6
    v_lshrrev_b32 v7, 16, v7
    v_mul_u32_u24 v8, 5, v7
    v_sub_u32 v8, v6, v8
    v_lshlrev_b32 v9, 6, v7
    v_add_u32 v9, s45, v9
    v_mul_lo_u32 v10, v9, s42
    v_add_u32 v10, s43, v10
    v_lshrrev_b32 v11, 1, v8
    v_lshl_add_u32 v11, v11, 5, v3
    v_lshl_add_u32 v10, v11, 4, v10
    v_and_b32 v11, 1, v8
    v_lshl_add_u32 v10, v11, 3, v10
    v_lshl_add_u32 v12, v9, 8, s44
    v_lshl_add_u32 v12, v3, 3, v12
    v_cmp_eq_u32 vcc, 4, v8
    v_mov_b32 v13, s42
    v_mov_b32 v14, 256
    v_cndmask_b32 v10, v10, v12, vcc
    v_cndmask_b32 v13, v13, v14, vcc
    v_add_u32 v13, v10, v13
    v_cvt_pk_bf16_f32 v16, v84, v85
    v_cvt_pk_bf16_f32 v17, v86, v87
    buffer_store_dwordx2 v[16:17], v10, s[20:23], 0 offen
    s_nop 0
    v_cvt_pk_bf16_f32 v16, v116, v117
    v_cvt_pk_bf16_f32 v17, v118, v119
    buffer_store_dwordx2 v[16:17], v13, s[20:23], 0 offen
    s_nop 0
    v_add_u32 v6, 12, v5
    v_mul_u32_u24 v7, 13108, v6
    v_lshrrev_b32 v7, 16, v7
    v_mul_u32_u24 v8, 5, v7
    v_sub_u32 v8, v6, v8
    v_lshlrev_b32 v9, 6, v7
    v_add_u32 v9, s45, v9
    v_mul_lo_u32 v10, v9, s42
    v_add_u32 v10, s43, v10
    v_lshrrev_b32 v11, 1, v8
    v_lshl_add_u32 v11, v11, 5, v3
    v_lshl_add_u32 v10, v11, 4, v10
    v_and_b32 v11, 1, v8
    v_lshl_add_u32 v10, v11, 3, v10
    v_lshl_add_u32 v12, v9, 8, s44
    v_lshl_add_u32 v12, v3, 3, v12
    v_cmp_eq_u32 vcc, 4, v8
    v_mov_b32 v13, s42
    v_mov_b32 v14, 256
    v_cndmask_b32 v10, v10, v12, vcc
    v_cndmask_b32 v13, v13, v14, vcc
    v_add_u32 v13, v10, v13
    v_cvt_pk_bf16_f32 v16, v88, v89
    v_cvt_pk_bf16_f32 v17, v90, v91
    buffer_store_dwordx2 v[16:17], v10, s[20:23], 0 offen
    s_nop 0
    v_cvt_pk_bf16_f32 v16, v120, v121
    v_cvt_pk_bf16_f32 v17, v122, v123
    buffer_store_dwordx2 v[16:17], v13, s[20:23], 0 offen
    s_nop 0
    v_add_u32 v6, 14, v5
    v_mul_u32_u24 v7, 13108, v6
    v_lshrrev_b32 v7, 16, v7
    v_mul_u32_u24 v8, 5, v7
    v_sub_u32 v8, v6, v8
    v_lshlrev_b32 v9, 6, v7
    v_add_u32 v9, s45, v9
    v_mul_lo_u32 v10, v9, s42
    v_add_u32 v10, s43, v10
    v_lshrrev_b32 v11, 1, v8
    v_lshl_add_u32 v11, v11, 5, v3
    v_lshl_add_u32 v10, v11, 4, v10
    v_and_b32 v11, 1, v8
    v_lshl_add_u32 v10, v11, 3, v10
    v_lshl_add_u32 v12, v9, 8, s44
    v_lshl_add_u32 v12, v3, 3, v12
    v_cmp_eq_u32 vcc, 4, v8
    v_mov_b32 v13, s42
    v_mov_b32 v14, 256
    v_cndmask_b32 v10, v10, v12, vcc
    v_cndmask_b32 v13, v13, v14, vcc
    v_add_u32 v13, v10, v13
    v_cvt_pk_bf16_f32 v16, v92, v93
    v_cvt_pk_bf16_f32 v17, v94, v95
    buffer_store_dwordx2 v[16:17], v10, s[20:23], 0 offen
    s_nop 0
    v_cvt_pk_bf16_f32 v16, v124, v125
    v_cvt_pk_bf16_f32 v17, v126, v127
    buffer_store_dwordx2 v[16:17], v13, s[20:23], 0 offen
    s_nop 0
    s_waitcnt vmcnt(0)
    s_branch K1_END
K1_VLOOP:
    ds_read_b128 v[128:131], v204 offset:0
    ds_read_b128 v[132:135], v204 offset:4096
    ds_read_b64_tr_b16 v[136:137], v208 offset:0
    ds_read_b64_tr_b16 v[138:139], v208 offset:1024
    ds_read_b64_tr_b16 v[140:141], v209 offset:0
    ds_read_b64_tr_b16 v[142:143], v209 offset:1024
    s_add_u32 m0, s38, 98304
    s_movk_i32 s37, 256
    buffer_load_dwordx4 v200, s[12:15], s37 offen lds
    s_add_u32 m0, s38, 99328
    s_movk_i32 s37, 10496
    buffer_load_dwordx4 v201, s[12:15], s37 offen lds
    s_add_u32 m0, s38, 100352
    s_movk_i32 s37, 20736
    buffer_load_dwordx4 v200, s[12:15], s37 offen lds
    s_add_u32 m0, s38, 101376
    s_movk_i32 s37, 30976
    buffer_load_dwordx4 v201, s[12:15], s37 offen lds
    s_add_u32 m0, s39, 98304
    s_mov_b32 s37, 491520
    buffer_load_dwordx4 v203, s[16:19], s37 offen lds
    s_add_u32 m0, s39, 99328
    s_mov_b32 s37, 506880
    buffer_load_dwordx4 v203, s[16:19], s37 offen lds
    s_waitcnt lgkmcnt(0)
    v_mfma_f32_32x32x16_bf16 v[64:79], v[128:131], v[136:139], v[64:79]
    ds_read_b128 v[144:147], v205 offset:0
    ds_read_b128 v[148:151], v205 offset:4096
    v_mfma_f32_32x32x16_bf16 v[80:95], v[128:131], v[140:143], v[80:95]
    ds_read_b64_tr_b16 v[152:153], v208 offset:4096
    ds_read_b64_tr_b16 v[154:155], v208 offset:5120
    v_mfma_f32_32x32x16_bf16 v[96:111], v[132:135], v[136:139], v[96:111]
    ds_read_b64_tr_b16 v[156:157], v209 offset:4096
    ds_read_b64_tr_b16 v[158:159], v209 offset:5120
    v_mfma_f32_32x32x16_bf16 v[112:127], v[132:135], v[140:143], v[112:127]
    s_waitcnt lgkmcnt(0)
    v_mfma_f32_32x32x16_bf16 v[64:79], v[144:147], v[152:155], v[64:79]
    ds_read_b128 v[128:131], v206 offset:0
    ds_read_b128 v[132:135], v206 offset:4096
    v_mfma_f32_32x32x16_bf16 v[80:95], v[144:147], v[156:159], v[80:95]
    ds_read_b64_tr_b16 v[136:137], v208 offset:8192
    ds_read_b64_tr_b16 v[138:139], v208 offset:9216
    v_mfma_f32_32x32x16_bf16 v[96:111], v[148:151], v[152:155], v[96:111]
    ds_read_b64_tr_b16 v[140:141], v209 offset:8192
    ds_read_b64_tr_b16 v[142:143], v209 offset:9216
    v_mfma_f32_32x32x16_bf16 v[112:127], v[148:151], v[156:159], v[112:127]
    s_waitcnt lgkmcnt(0)
    v_mfma_f32_32x32x16_bf16 v[64:79], v[128:131], v[136:139], v[64:79]
    ds_read_b128 v[144:147], v207 offset:0
    ds_read_b128 v[148:151], v207 offset:4096
    v_mfma_f32_32x32x16_bf16 v[80:95], v[128:131], v[140:143], v[80:95]
    ds_read_b64_tr_b16 v[152:153], v208 offset:12288
    ds_read_b64_tr_b16 v[154:155], v208 offset:13312
    v_mfma_f32_32x32x16_bf16 v[96:111], v[132:135], v[136:139], v[96:111]
    ds_read_b64_tr_b16 v[156:157], v209 offset:12288
    ds_read_b64_tr_b16 v[158:159], v209 offset:13312
    v_mfma_f32_32x32x16_bf16 v[112:127], v[132:135], v[140:143], v[112:127]
    s_waitcnt lgkmcnt(0)
    v_mfma_f32_32x32x16_bf16 v[64:79], v[144:147], v[152:155], v[64:79]
    v_mfma_f32_32x32x16_bf16 v[80:95], v[144:147], v[156:159], v[80:95]
    v_mfma_f32_32x32x16_bf16 v[96:111], v[148:151], v[152:155], v[96:111]
    v_mfma_f32_32x32x16_bf16 v[112:127], v[148:151], v[156:159], v[112:127]
    s_waitcnt vmcnt(6)
    s_barrier
    ds_read_b128 v[128:131], v212 offset:0
    ds_read_b128 v[132:135], v212 offset:4096
    ds_read_b64_tr_b16 v[136:137], v216 offset:0
    ds_read_b64_tr_b16 v[138:139], v216 offset:1024
    ds_read_b64_tr_b16 v[140:141], v217 offset:0
    ds_read_b64_tr_b16 v[142:143], v217 offset:1024
    s_add_u32 m0, s38, 0
    s_movk_i32 s37, 384
    buffer_load_dwordx4 v200, s[12:15], s37 offen lds
    s_add_u32 m0, s38, 1024
    s_movk_i32 s37, 10624
    buffer_load_dwordx4 v201, s[12:15], s37 offen lds
    s_add_u32 m0, s38, 2048
    s_movk_i32 s37, 20864
    buffer_load_dwordx4 v200, s[12:15], s37 offen lds
    s_add_u32 m0, s38, 3072
    s_movk_i32 s37, 31104
    buffer_load_dwordx4 v201, s[12:15], s37 offen lds
    s_add_u32 m0, s39, 0
    s_mov_b32 s37, 737280
    buffer_load_dwordx4 v203, s[16:19], s37 offen lds
    s_add_u32 m0, s39, 1024
    s_mov_b32 s37, 752640
    buffer_load_dwordx4 v203, s[16:19], s37 offen lds
    s_waitcnt lgkmcnt(0)
    v_mfma_f32_32x32x16_bf16 v[64:79], v[128:131], v[136:139], v[64:79]
    ds_read_b128 v[144:147], v213 offset:0
    ds_read_b128 v[148:151], v213 offset:4096
    v_mfma_f32_32x32x16_bf16 v[80:95], v[128:131], v[140:143], v[80:95]
    ds_read_b64_tr_b16 v[152:153], v216 offset:4096
    ds_read_b64_tr_b16 v[154:155], v216 offset:5120
    v_mfma_f32_32x32x16_bf16 v[96:111], v[132:135], v[136:139], v[96:111]
    ds_read_b64_tr_b16 v[156:157], v217 offset:4096
    ds_read_b64_tr_b16 v[158:159], v217 offset:5120
    v_mfma_f32_32x32x16_bf16 v[112:127], v[132:135], v[140:143], v[112:127]
    s_waitcnt lgkmcnt(0)
    v_mfma_f32_32x32x16_bf16 v[64:79], v[144:147], v[152:155], v[64:79]
    ds_read_b128 v[128:131], v214 offset:0
    ds_read_b128 v[132:135], v214 offset:4096
    v_mfma_f32_32x32x16_bf16 v[80:95], v[144:147], v[156:159], v[80:95]
    ds_read_b64_tr_b16 v[136:137], v216 offset:8192
    ds_read_b64_tr_b16 v[138:139], v216 offset:9216
    v_mfma_f32_32x32x16_bf16 v[96:111], v[148:151], v[152:155], v[96:111]
    ds_read_b64_tr_b16 v[140:141], v217 offset:8192
    ds_read_b64_tr_b16 v[142:143], v217 offset:9216
    v_mfma_f32_32x32x16_bf16 v[112:127], v[148:151], v[156:159], v[112:127]
    s_waitcnt lgkmcnt(0)
    v_mfma_f32_32x32x16_bf16 v[64:79], v[128:131], v[136:139], v[64:79]
    ds_read_b128 v[144:147], v215 offset:0
    ds_read_b128 v[148:151], v215 offset:4096
    v_mfma_f32_32x32x16_bf16 v[80:95], v[128:131], v[140:143], v[80:95]
    ds_read_b64_tr_b16 v[152:153], v216 offset:12288
    ds_read_b64_tr_b16 v[154:155], v216 offset:13312
    v_mfma_f32_32x32x16_bf16 v[96:111], v[132:135], v[136:139], v[96:111]
    ds_read_b64_tr_b16 v[156:157], v217 offset:12288
    ds_read_b64_tr_b16 v[158:159], v217 offset:13312
    v_mfma_f32_32x32x16_bf16 v[112:127], v[132:135], v[140:143], v[112:127]
    s_waitcnt lgkmcnt(0)
    v_mfma_f32_32x32x16_bf16 v[64:79], v[144:147], v[152:155], v[64:79]
    v_mfma_f32_32x32x16_bf16 v[80:95], v[144:147], v[156:159], v[80:95]
    v_mfma_f32_32x32x16_bf16 v[96:111], v[148:151], v[152:155], v[96:111]
    v_mfma_f32_32x32x16_bf16 v[112:127], v[148:151], v[156:159], v[112:127]
    s_waitcnt vmcnt(6)
    s_barrier
    ds_read_b128 v[128:131], v220 offset:0
    ds_read_b128 v[132:135], v220 offset:4096
    ds_read_b64_tr_b16 v[136:137], v224 offset:0
    ds_read_b64_tr_b16 v[138:139], v224 offset:1024
    ds_read_b64_tr_b16 v[140:141], v225 offset:0
    ds_read_b64_tr_b16 v[142:143], v225 offset:1024
    s_add_u32 m0, s38, 49152
    s_movk_i32 s37, 512
    buffer_load_dwordx4 v200, s[12:15], s37 offen lds
    s_add_u32 m0, s38, 50176
    s_movk_i32 s37, 10752
    buffer_load_dwordx4 v201, s[12:15], s37 offen lds
    s_add_u32 m0, s38, 51200
    s_movk_i32 s37, 20992
    buffer_load_dwordx4 v200, s[12:15], s37 offen lds
    s_add_u32 m0, s38, 52224
    s_movk_i32 s37, 31232
    buffer_load_dwordx4 v201, s[12:15], s37 offen lds
    s_add_u32 m0, s39, 49152
    s_mov_b32 s37, 983040
    buffer_load_dwordx4 v203, s[16:19], s37 offen lds
    s_add_u32 m0, s39, 50176
    s_mov_b32 s37, 998400
    buffer_load_dwordx4 v203, s[16:19], s37 offen lds
    s_waitcnt lgkmcnt(0)
    v_mfma_f32_32x32x16_bf16 v[64:79], v[128:131], v[136:139], v[64:79]
    ds_read_b128 v[144:147], v221 offset:0
    ds_read_b128 v[148:151], v221 offset:4096
    v_mfma_f32_32x32x16_bf16 v[80:95], v[128:131], v[140:143], v[80:95]
    ds_read_b64_tr_b16 v[152:153], v224 offset:4096
    ds_read_b64_tr_b16 v[154:155], v224 offset:5120
    v_mfma_f32_32x32x16_bf16 v[96:111], v[132:135], v[136:139], v[96:111]
    ds_read_b64_tr_b16 v[156:157], v225 offset:4096
    ds_read_b64_tr_b16 v[158:159], v225 offset:5120
    v_mfma_f32_32x32x16_bf16 v[112:127], v[132:135], v[140:143], v[112:127]
    s_waitcnt lgkmcnt(0)
    v_mfma_f32_32x32x16_bf16 v[64:79], v[144:147], v[152:155], v[64:79]
    ds_read_b128 v[128:131], v222 offset:0
    ds_read_b128 v[132:135], v222 offset:4096
    v_mfma_f32_32x32x16_bf16 v[80:95], v[144:147], v[156:159], v[80:95]
    ds_read_b64_tr_b16 v[136:137], v224 offset:8192
    ds_read_b64_tr_b16 v[138:139], v224 offset:9216
    v_mfma_f32_32x32x16_bf16 v[96:111], v[148:151], v[152:155], v[96:111]
    ds_read_b64_tr_b16 v[140:141], v225 offset:8192
    ds_read_b64_tr_b16 v[142:143], v225 offset:9216
    v_mfma_f32_32x32x16_bf16 v[112:127], v[148:151], v[156:159], v[112:127]
    s_waitcnt lgkmcnt(0)
    v_mfma_f32_32x32x16_bf16 v[64:79], v[128:131], v[136:139], v[64:79]
    ds_read_b128 v[144:147], v223 offset:0
    ds_read_b128 v[148:151], v223 offset:4096
    v_mfma_f32_32x32x16_bf16 v[80:95], v[128:131], v[140:143], v[80:95]
    ds_read_b64_tr_b16 v[152:153], v224 offset:12288
    ds_read_b64_tr_b16 v[154:155], v224 offset:13312
    v_mfma_f32_32x32x16_bf16 v[96:111], v[132:135], v[136:139], v[96:111]
    ds_read_b64_tr_b16 v[156:157], v225 offset:12288
    ds_read_b64_tr_b16 v[158:159], v225 offset:13312
    v_mfma_f32_32x32x16_bf16 v[112:127], v[132:135], v[140:143], v[112:127]
    s_waitcnt lgkmcnt(0)
    v_mfma_f32_32x32x16_bf16 v[64:79], v[144:147], v[152:155], v[64:79]
    v_mfma_f32_32x32x16_bf16 v[80:95], v[144:147], v[156:159], v[80:95]
    v_mfma_f32_32x32x16_bf16 v[96:111], v[148:151], v[152:155], v[96:111]
    v_mfma_f32_32x32x16_bf16 v[112:127], v[148:151], v[156:159], v[112:127]
    s_waitcnt vmcnt(6)
    s_barrier
    ds_read_b128 v[128:131], v204 offset:0
    ds_read_b128 v[132:135], v204 offset:4096
    ds_read_b64_tr_b16 v[136:137], v208 offset:0
    ds_read_b64_tr_b16 v[138:139], v208 offset:1024
    ds_read_b64_tr_b16 v[140:141], v209 offset:0
    ds_read_b64_tr_b16 v[142:143], v209 offset:1024
    s_add_u32 m0, s38, 98304
    s_movk_i32 s37, 640
    buffer_load_dwordx4 v200, s[12:15], s37 offen lds
    s_add_u32 m0, s38, 99328
    s_movk_i32 s37, 10880
    buffer_load_dwordx4 v201, s[12:15], s37 offen lds
    s_add_u32 m0, s38, 100352
    s_movk_i32 s37, 21120
    buffer_load_dwordx4 v200, s[12:15], s37 offen lds
    s_add_u32 m0, s38, 101376
    s_movk_i32 s37, 31360
    buffer_load_dwordx4 v201, s[12:15], s37 offen lds
    s_add_u32 m0, s39, 98304
    s_mov_b32 s37, 1228800
    buffer_load_dwordx4 v203, s[16:19], s37 offen lds
    s_add_u32 m0, s39, 99328
    s_mov_b32 s37, 1244160
    buffer_load_dwordx4 v203, s[16:19], s37 offen lds
    s_waitcnt lgkmcnt(0)
    v_mfma_f32_32x32x16_bf16 v[64:79], v[128:131], v[136:139], v[64:79]
    ds_read_b128 v[144:147], v205 offset:0
    ds_read_b128 v[148:151], v205 offset:4096
    v_mfma_f32_32x32x16_bf16 v[80:95], v[128:131], v[140:143], v[80:95]
    ds_read_b64_tr_b16 v[152:153], v208 offset:4096
    ds_read_b64_tr_b16 v[154:155], v208 offset:5120
    v_mfma_f32_32x32x16_bf16 v[96:111], v[132:135], v[136:139], v[96:111]
    ds_read_b64_tr_b16 v[156:157], v209 offset:4096
    ds_read_b64_tr_b16 v[158:159], v209 offset:5120
    v_mfma_f32_32x32x16_bf16 v[112:127], v[132:135], v[140:143], v[112:127]
    s_waitcnt lgkmcnt(0)
    v_mfma_f32_32x32x16_bf16 v[64:79], v[144:147], v[152:155], v[64:79]
    ds_read_b128 v[128:131], v206 offset:0
    ds_read_b128 v[132:135], v206 offset:4096
    v_mfma_f32_32x32x16_bf16 v[80:95], v[144:147], v[156:159], v[80:95]
    ds_read_b64_tr_b16 v[136:137], v208 offset:8192
    ds_read_b64_tr_b16 v[138:139], v208 offset:9216
    v_mfma_f32_32x32x16_bf16 v[96:111], v[148:151], v[152:155], v[96:111]
    ds_read_b64_tr_b16 v[140:141], v209 offset:8192
    ds_read_b64_tr_b16 v[142:143], v209 offset:9216
    v_mfma_f32_32x32x16_bf16 v[112:127], v[148:151], v[156:159], v[112:127]
    s_waitcnt lgkmcnt(0)
    v_mfma_f32_32x32x16_bf16 v[64:79], v[128:131], v[136:139], v[64:79]
    ds_read_b128 v[144:147], v207 offset:0
    ds_read_b128 v[148:151], v207 offset:4096
    v_mfma_f32_32x32x16_bf16 v[80:95], v[128:131], v[140:143], v[80:95]
    ds_read_b64_tr_b16 v[152:153], v208 offset:12288
    ds_read_b64_tr_b16 v[154:155], v208 offset:13312
    v_mfma_f32_32x32x16_bf16 v[96:111], v[132:135], v[136:139], v[96:111]
    ds_read_b64_tr_b16 v[156:157], v209 offset:12288
    ds_read_b64_tr_b16 v[158:159], v209 offset:13312
    v_mfma_f32_32x32x16_bf16 v[112:127], v[132:135], v[140:143], v[112:127]
    s_waitcnt lgkmcnt(0)
    v_mfma_f32_32x32x16_bf16 v[64:79], v[144:147], v[152:155], v[64:79]
    v_mfma_f32_32x32x16_bf16 v[80:95], v[144:147], v[156:159], v[80:95]
    v_mfma_f32_32x32x16_bf16 v[96:111], v[148:151], v[152:155], v[96:111]
    v_mfma_f32_32x32x16_bf16 v[112:127], v[148:151], v[156:159], v[112:127]
    s_waitcnt vmcnt(6)
    s_barrier
    ds_read_b128 v[128:131], v212 offset:0
    ds_read_b128 v[132:135], v212 offset:4096
    ds_read_b64_tr_b16 v[136:137], v216 offset:0
    ds_read_b64_tr_b16 v[138:139], v216 offset:1024
    ds_read_b64_tr_b16 v[140:141], v217 offset:0
    ds_read_b64_tr_b16 v[142:143], v217 offset:1024
    s_add_u32 m0, s38, 0
    s_movk_i32 s37, 768
    buffer_load_dwordx4 v200, s[12:15], s37 offen lds
    s_add_u32 m0, s38, 1024
    s_movk_i32 s37, 11008
    buffer_load_dwordx4 v201, s[12:15], s37 offen lds
    s_add_u32 m0, s38, 2048
    s_movk_i32 s37, 21248
    buffer_load_dwordx4 v200, s[12:15], s37 offen lds
    s_add_u32 m0, s38, 3072
    s_movk_i32 s37, 31488
    buffer_load_dwordx4 v201, s[12:15], s37 offen lds
    s_add_u32 m0, s39, 0
    s_mov_b32 s37, 1474560
    buffer_load_dwordx4 v203, s[16:19], s37 offen lds
    s_add_u32 m0, s39, 1024
    s_mov_b32 s37, 1489920
    buffer_load_dwordx4 v203, s[16:19], s37 offen lds
    s_waitcnt lgkmcnt(0)
    v_mfma_f32_32x32x16_bf16 v[64:79], v[128:131], v[136:139], v[64:79]
    ds_read_b128 v[144:147], v213 offset:0
    ds_read_b128 v[148:151], v213 offset:4096
    v_mfma_f32_32x32x16_bf16 v[80:95], v[128:131], v[140:143], v[80:95]
    ds_read_b64_tr_b16 v[152:153], v216 offset:4096
    ds_read_b64_tr_b16 v[154:155], v216 offset:5120
    v_mfma_f32_32x32x16_bf16 v[96:111], v[132:135], v[136:139], v[96:111]
    ds_read_b64_tr_b16 v[156:157], v217 offset:4096
    ds_read_b64_tr_b16 v[158:159], v217 offset:5120
    v_mfma_f32_32x32x16_bf16 v[112:127], v[132:135], v[140:143], v[112:127]
    s_waitcnt lgkmcnt(0)
    v_mfma_f32_32x32x16_bf16 v[64:79], v[144:147], v[152:155], v[64:79]
    ds_read_b128 v[128:131], v214 offset:0
    ds_read_b128 v[132:135], v214 offset:4096
    v_mfma_f32_32x32x16_bf16 v[80:95], v[144:147], v[156:159], v[80:95]
    ds_read_b64_tr_b16 v[136:137], v216 offset:8192
    ds_read_b64_tr_b16 v[138:139], v216 offset:9216
    v_mfma_f32_32x32x16_bf16 v[96:111], v[148:151], v[152:155], v[96:111]
    ds_read_b64_tr_b16 v[140:141], v217 offset:8192
    ds_read_b64_tr_b16 v[142:143], v217 offset:9216
    v_mfma_f32_32x32x16_bf16 v[112:127], v[148:151], v[156:159], v[112:127]
    s_waitcnt lgkmcnt(0)
    v_mfma_f32_32x32x16_bf16 v[64:79], v[128:131], v[136:139], v[64:79]
    ds_read_b128 v[144:147], v215 offset:0
    ds_read_b128 v[148:151], v215 offset:4096
    v_mfma_f32_32x32x16_bf16 v[80:95], v[128:131], v[140:143], v[80:95]
    ds_read_b64_tr_b16 v[152:153], v216 offset:12288
    ds_read_b64_tr_b16 v[154:155], v216 offset:13312
    v_mfma_f32_32x32x16_bf16 v[96:111], v[132:135], v[136:139], v[96:111]
    ds_read_b64_tr_b16 v[156:157], v217 offset:12288
    ds_read_b64_tr_b16 v[158:159], v217 offset:13312
    v_mfma_f32_32x32x16_bf16 v[112:127], v[132:135], v[140:143], v[112:127]
    s_waitcnt lgkmcnt(0)
    v_mfma_f32_32x32x16_bf16 v[64:79], v[144:147], v[152:155], v[64:79]
    v_mfma_f32_32x32x16_bf16 v[80:95], v[144:147], v[156:159], v[80:95]
    v_mfma_f32_32x32x16_bf16 v[96:111], v[148:151], v[152:155], v[96:111]
    v_mfma_f32_32x32x16_bf16 v[112:127], v[148:151], v[156:159], v[112:127]
    s_waitcnt vmcnt(6)
    s_barrier
    ds_read_b128 v[128:131], v220 offset:0
    ds_read_b128 v[132:135], v220 offset:4096
    ds_read_b64_tr_b16 v[136:137], v224 offset:0
    ds_read_b64_tr_b16 v[138:139], v224 offset:1024
    ds_read_b64_tr_b16 v[140:141], v225 offset:0
    ds_read_b64_tr_b16 v[142:143], v225 offset:1024
    s_add_u32 m0, s38, 49152
    s_movk_i32 s37, 896
    buffer_load_dwordx4 v200, s[12:15], s37 offen lds
    s_add_u32 m0, s38, 50176
    s_movk_i32 s37, 11136
    buffer_load_dwordx4 v201, s[12:15], s37 offen lds
    s_add_u32 m0, s38, 51200
    s_movk_i32 s37, 21376
    buffer_load_dwordx4 v200, s[12:15], s37 offen lds
    s_add_u32 m0, s38, 52224
    s_movk_i32 s37, 31616
    buffer_load_dwordx4 v201, s[12:15], s37 offen lds
    s_add_u32 m0, s39, 49152
    s_mov_b32 s37, 1720320
    buffer_load_dwordx4 v203, s[16:19], s37 offen lds
    s_add_u32 m0, s39, 50176
    s_mov_b32 s37, 1735680
    buffer_load_dwordx4 v203, s[16:19], s37 offen lds
    s_waitcnt lgkmcnt(0)
    v_mfma_f32_32x32x16_bf16 v[64:79], v[128:131], v[136:139], v[64:79]
    ds_read_b128 v[144:147], v221 offset:0
    ds_read_b128 v[148:151], v221 offset:4096
    v_mfma_f32_32x32x16_bf16 v[80:95], v[128:131], v[140:143], v[80:95]
    ds_read_b64_tr_b16 v[152:153], v224 offset:4096
    ds_read_b64_tr_b16 v[154:155], v224 offset:5120
    v_mfma_f32_32x32x16_bf16 v[96:111], v[132:135], v[136:139], v[96:111]
    ds_read_b64_tr_b16 v[156:157], v225 offset:4096
    ds_read_b64_tr_b16 v[158:159], v225 offset:5120
    v_mfma_f32_32x32x16_bf16 v[112:127], v[132:135], v[140:143], v[112:127]
    s_waitcnt lgkmcnt(0)
    v_mfma_f32_32x32x16_bf16 v[64:79], v[144:147], v[152:155], v[64:79]
    ds_read_b128 v[128:131], v222 offset:0
    ds_read_b128 v[132:135], v222 offset:4096
    v_mfma_f32_32x32x16_bf16 v[80:95], v[144:147], v[156:159], v[80:95]
    ds_read_b64_tr_b16 v[136:137], v224 offset:8192
    ds_read_b64_tr_b16 v[138:139], v224 offset:9216
    v_mfma_f32_32x32x16_bf16 v[96:111], v[148:151], v[152:155], v[96:111]
    ds_read_b64_tr_b16 v[140:141], v225 offset:8192
    ds_read_b64_tr_b16 v[142:143], v225 offset:9216
    v_mfma_f32_32x32x16_bf16 v[112:127], v[148:151], v[156:159], v[112:127]
    s_waitcnt lgkmcnt(0)
    v_mfma_f32_32x32x16_bf16 v[64:79], v[128:131], v[136:139], v[64:79]
    ds_read_b128 v[144:147], v223 offset:0
    ds_read_b128 v[148:151], v223 offset:4096
    v_mfma_f32_32x32x16_bf16 v[80:95], v[128:131], v[140:143], v[80:95]
    ds_read_b64_tr_b16 v[152:153], v224 offset:12288
    ds_read_b64_tr_b16 v[154:155], v224 offset:13312
    v_mfma_f32_32x32x16_bf16 v[96:111], v[132:135], v[136:139], v[96:111]
    ds_read_b64_tr_b16 v[156:157], v225 offset:12288
    ds_read_b64_tr_b16 v[158:159], v225 offset:13312
    v_mfma_f32_32x32x16_bf16 v[112:127], v[132:135], v[140:143], v[112:127]
    s_waitcnt lgkmcnt(0)
    v_mfma_f32_32x32x16_bf16 v[64:79], v[144:147], v[152:155], v[64:79]
    v_mfma_f32_32x32x16_bf16 v[80:95], v[144:147], v[156:159], v[80:95]
    v_mfma_f32_32x32x16_bf16 v[96:111], v[148:151], v[152:155], v[96:111]
    v_mfma_f32_32x32x16_bf16 v[112:127], v[148:151], v[156:159], v[112:127]
    s_waitcnt vmcnt(6)
    s_barrier
    ds_read_b128 v[128:131], v204 offset:0
    ds_read_b128 v[132:135], v204 offset:4096
    ds_read_b64_tr_b16 v[136:137], v208 offset:0
    ds_read_b64_tr_b16 v[138:139], v208 offset:1024
    ds_read_b64_tr_b16 v[140:141], v209 offset:0
    ds_read_b64_tr_b16 v[142:143], v209 offset:1024
    s_add_u32 m0, s38, 98304
    s_movk_i32 s37, 1024
    buffer_load_dwordx4 v200, s[12:15], s37 offen lds
    s_add_u32 m0, s38, 99328
    s_movk_i32 s37, 11264
    buffer_load_dwordx4 v201, s[12:15], s37 offen lds
    s_add_u32 m0, s38, 100352
    s_movk_i32 s37, 21504
    buffer_load_dwordx4 v200, s[12:15], s37 offen lds
    s_add_u32 m0, s38, 101376
    s_movk_i32 s37, 31744
    buffer_load_dwordx4 v201, s[12:15], s37 offen lds
    s_add_u32 m0, s39, 98304
    s_mov_b32 s37, 1966080
    buffer_load_dwordx4 v203, s[16:19], s37 offen lds
    s_add_u32 m0, s39, 99328
    s_mov_b32 s37, 1981440
    buffer_load_dwordx4 v203, s[16:19], s37 offen lds
    s_waitcnt lgkmcnt(0)
    v_mfma_f32_32x32x16_bf16 v[64:79], v[128:131], v[136:139], v[64:79]
    ds_read_b128 v[144:147], v205 offset:0
    ds_read_b128 v[148:151], v205 offset:4096
    v_mfma_f32_32x32x16_bf16 v[80:95], v[128:131], v[140:143], v[80:95]
    ds_read_b64_tr_b16 v[152:153], v208 offset:4096
    ds_read_b64_tr_b16 v[154:155], v208 offset:5120
    v_mfma_f32_32x32x16_bf16 v[96:111], v[132:135], v[136:139], v[96:111]
    ds_read_b64_tr_b16 v[156:157], v209 offset:4096
    ds_read_b64_tr_b16 v[158:159], v209 offset:5120
    v_mfma_f32_32x32x16_bf16 v[112:127], v[132:135], v[140:143], v[112:127]
    s_waitcnt lgkmcnt(0)
    v_mfma_f32_32x32x16_bf16 v[64:79], v[144:147], v[152:155], v[64:79]
    ds_read_b128 v[128:131], v206 offset:0
    ds_read_b128 v[132:135], v206 offset:4096
    v_mfma_f32_32x32x16_bf16 v[80:95], v[144:147], v[156:159], v[80:95]
    ds_read_b64_tr_b16 v[136:137], v208 offset:8192
    ds_read_b64_tr_b16 v[138:139], v208 offset:9216
    v_mfma_f32_32x32x16_bf16 v[96:111], v[148:151], v[152:155], v[96:111]
    ds_read_b64_tr_b16 v[140:141], v209 offset:8192
    ds_read_b64_tr_b16 v[142:143], v209 offset:9216
    v_mfma_f32_32x32x16_bf16 v[112:127], v[148:151], v[156:159], v[112:127]
    s_waitcnt lgkmcnt(0)
    v_mfma_f32_32x32x16_bf16 v[64:79], v[128:131], v[136:139], v[64:79]
    ds_read_b128 v[144:147], v207 offset:0
    ds_read_b128 v[148:151], v207 offset:4096
    v_mfma_f32_32x32x16_bf16 v[80:95], v[128:131], v[140:143], v[80:95]
    ds_read_b64_tr_b16 v[152:153], v208 offset:12288
    ds_read_b64_tr_b16 v[154:155], v208 offset:13312
    v_mfma_f32_32x32x16_bf16 v[96:111], v[132:135], v[136:139], v[96:111]
    ds_read_b64_tr_b16 v[156:157], v209 offset:12288
    ds_read_b64_tr_b16 v[158:159], v209 offset:13312
    v_mfma_f32_32x32x16_bf16 v[112:127], v[132:135], v[140:143], v[112:127]
    s_waitcnt lgkmcnt(0)
    v_mfma_f32_32x32x16_bf16 v[64:79], v[144:147], v[152:155], v[64:79]
    v_mfma_f32_32x32x16_bf16 v[80:95], v[144:147], v[156:159], v[80:95]
    v_mfma_f32_32x32x16_bf16 v[96:111], v[148:151], v[152:155], v[96:111]
    v_mfma_f32_32x32x16_bf16 v[112:127], v[148:151], v[156:159], v[112:127]
    s_waitcnt vmcnt(6)
    s_barrier
    ds_read_b128 v[128:131], v212 offset:0
    ds_read_b128 v[132:135], v212 offset:4096
    ds_read_b64_tr_b16 v[136:137], v216 offset:0
    ds_read_b64_tr_b16 v[138:139], v216 offset:1024
    ds_read_b64_tr_b16 v[140:141], v217 offset:0
    ds_read_b64_tr_b16 v[142:143], v217 offset:1024
    s_add_u32 m0, s38, 0
    s_movk_i32 s37, 1152
    buffer_load_dwordx4 v200, s[12:15], s37 offen lds
    s_add_u32 m0, s38, 1024
    s_movk_i32 s37, 11392
    buffer_load_dwordx4 v201, s[12:15], s37 offen lds
    s_add_u32 m0, s38, 2048
    s_movk_i32 s37, 21632
    buffer_load_dwordx4 v200, s[12:15], s37 offen lds
    s_add_u32 m0, s38, 3072
    s_movk_i32 s37, 31872
    buffer_load_dwordx4 v201, s[12:15], s37 offen lds
    s_add_u32 m0, s39, 0
    s_mov_b32 s37, 2211840
    buffer_load_dwordx4 v203, s[16:19], s37 offen lds
    s_add_u32 m0, s39, 1024
    s_mov_b32 s37, 2227200
    buffer_load_dwordx4 v203, s[16:19], s37 offen lds
    s_waitcnt lgkmcnt(0)
    v_mfma_f32_32x32x16_bf16 v[64:79], v[128:131], v[136:139], v[64:79]
    ds_read_b128 v[144:147], v213 offset:0
    ds_read_b128 v[148:151], v213 offset:4096
    v_mfma_f32_32x32x16_bf16 v[80:95], v[128:131], v[140:143], v[80:95]
    ds_read_b64_tr_b16 v[152:153], v216 offset:4096
    ds_read_b64_tr_b16 v[154:155], v216 offset:5120
    v_mfma_f32_32x32x16_bf16 v[96:111], v[132:135], v[136:139], v[96:111]
    ds_read_b64_tr_b16 v[156:157], v217 offset:4096
    ds_read_b64_tr_b16 v[158:159], v217 offset:5120
    v_mfma_f32_32x32x16_bf16 v[112:127], v[132:135], v[140:143], v[112:127]
    s_waitcnt lgkmcnt(0)
    v_mfma_f32_32x32x16_bf16 v[64:79], v[144:147], v[152:155], v[64:79]
    ds_read_b128 v[128:131], v214 offset:0
    ds_read_b128 v[132:135], v214 offset:4096
    v_mfma_f32_32x32x16_bf16 v[80:95], v[144:147], v[156:159], v[80:95]
    ds_read_b64_tr_b16 v[136:137], v216 offset:8192
    ds_read_b64_tr_b16 v[138:139], v216 offset:9216
    v_mfma_f32_32x32x16_bf16 v[96:111], v[148:151], v[152:155], v[96:111]
    ds_read_b64_tr_b16 v[140:141], v217 offset:8192
    ds_read_b64_tr_b16 v[142:143], v217 offset:9216
    v_mfma_f32_32x32x16_bf16 v[112:127], v[148:151], v[156:159], v[112:127]
    s_waitcnt lgkmcnt(0)
    v_mfma_f32_32x32x16_bf16 v[64:79], v[128:131], v[136:139], v[64:79]
    ds_read_b128 v[144:147], v215 offset:0
    ds_read_b128 v[148:151], v215 offset:4096
    v_mfma_f32_32x32x16_bf16 v[80:95], v[128:131], v[140:143], v[80:95]
    ds_read_b64_tr_b16 v[152:153], v216 offset:12288
    ds_read_b64_tr_b16 v[154:155], v216 offset:13312
    v_mfma_f32_32x32x16_bf16 v[96:111], v[132:135], v[136:139], v[96:111]
    ds_read_b64_tr_b16 v[156:157], v217 offset:12288
    ds_read_b64_tr_b16 v[158:159], v217 offset:13312
    v_mfma_f32_32x32x16_bf16 v[112:127], v[132:135], v[140:143], v[112:127]
    s_waitcnt lgkmcnt(0)
    v_mfma_f32_32x32x16_bf16 v[64:79], v[144:147], v[152:155], v[64:79]
    v_mfma_f32_32x32x16_bf16 v[80:95], v[144:147], v[156:159], v[80:95]
    v_mfma_f32_32x32x16_bf16 v[96:111], v[148:151], v[152:155], v[96:111]
    v_mfma_f32_32x32x16_bf16 v[112:127], v[148:151], v[156:159], v[112:127]
    s_waitcnt vmcnt(6)
    s_barrier
    ds_read_b128 v[128:131], v220 offset:0
    ds_read_b128 v[132:135], v220 offset:4096
    ds_read_b64_tr_b16 v[136:137], v224 offset:0
    ds_read_b64_tr_b16 v[138:139], v224 offset:1024
    ds_read_b64_tr_b16 v[140:141], v225 offset:0
    ds_read_b64_tr_b16 v[142:143], v225 offset:1024
    s_waitcnt lgkmcnt(0)
    v_mfma_f32_32x32x16_bf16 v[64:79], v[128:131], v[136:139], v[64:79]
    ds_read_b128 v[144:147], v221 offset:0
    ds_read_b128 v[148:151], v221 offset:4096
    v_mfma_f32_32x32x16_bf16 v[80:95], v[128:131], v[140:143], v[80:95]
    ds_read_b64_tr_b16 v[152:153], v224 offset:4096
    ds_read_b64_tr_b16 v[154:155], v224 offset:5120
    v_mfma_f32_32x32x16_bf16 v[96:111], v[132:135], v[136:139], v[96:111]
    ds_read_b64_tr_b16 v[156:157], v225 offset:4096
    ds_read_b64_tr_b16 v[158:159], v225 offset:5120
    v_mfma_f32_32x32x16_bf16 v[112:127], v[132:135], v[140:143], v[112:127]
    s_waitcnt lgkmcnt(0)
    v_mfma_f32_32x32x16_bf16 v[64:79], v[144:147], v[152:155], v[64:79]
    ds_read_b128 v[128:131], v222 offset:0
    ds_read_b128 v[132:135], v222 offset:4096
    v_mfma_f32_32x32x16_bf16 v[80:95], v[144:147], v[156:159], v[80:95]
    ds_read_b64_tr_b16 v[136:137], v224 offset:8192
    ds_read_b64_tr_b16 v[138:139], v224 offset:9216
    v_mfma_f32_32x32x16_bf16 v[96:111], v[148:151], v[152:155], v[96:111]
    ds_read_b64_tr_b16 v[140:141], v225 offset:8192
    ds_read_b64_tr_b16 v[142:143], v225 offset:9216
    v_mfma_f32_32x32x16_bf16 v[112:127], v[148:151], v[156:159], v[112:127]
    s_waitcnt lgkmcnt(0)
    v_mfma_f32_32x32x16_bf16 v[64:79], v[128:131], v[136:139], v[64:79]
    ds_read_b128 v[144:147], v223 offset:0
    ds_read_b128 v[148:151], v223 offset:4096
    v_mfma_f32_32x32x16_bf16 v[80:95], v[128:131], v[140:143], v[80:95]
    ds_read_b64_tr_b16 v[152:153], v224 offset:12288
    ds_read_b64_tr_b16 v[154:155], v224 offset:13312
    v_mfma_f32_32x32x16_bf16 v[96:111], v[132:135], v[136:139], v[96:111]
    ds_read_b64_tr_b16 v[156:157], v225 offset:12288
    ds_read_b64_tr_b16 v[158:159], v225 offset:13312
    v_mfma_f32_32x32x16_bf16 v[112:127], v[132:135], v[140:143], v[112:127]
    s_waitcnt lgkmcnt(0)
    v_mfma_f32_32x32x16_bf16 v[64:79], v[144:147], v[152:155], v[64:79]
    v_mfma_f32_32x32x16_bf16 v[80:95], v[144:147], v[156:159], v[80:95]
    v_mfma_f32_32x32x16_bf16 v[96:111], v[148:151], v[152:155], v[96:111]
    v_mfma_f32_32x32x16_bf16 v[112:127], v[148:151], v[156:159], v[112:127]
    s_waitcnt vmcnt(0)
    s_barrier
    ds_read_b128 v[128:131], v204 offset:0
    ds_read_b128 v[132:135], v204 offset:4096
    ds_read_b64_tr_b16 v[136:137], v208 offset:0
    ds_read_b64_tr_b16 v[138:139], v208 offset:1024
    ds_read_b64_tr_b16 v[140:141], v209 offset:0
    ds_read_b64_tr_b16 v[142:143], v209 offset:1024
    s_waitcnt lgkmcnt(0)
    v_mfma_f32_32x32x16_bf16 v[64:79], v[128:131], v[136:139], v[64:79]
    ds_read_b128 v[144:147], v205 offset:0
    ds_read_b128 v[148:151], v205 offset:4096
    v_mfma_f32_32x32x16_bf16 v[80:95], v[128:131], v[140:143], v[80:95]
    ds_read_b64_tr_b16 v[152:153], v208 offset:4096
    ds_read_b64_tr_b16 v[154:155], v208 offset:5120
    v_mfma_f32_32x32x16_bf16 v[96:111], v[132:135], v[136:139], v[96:111]
    ds_read_b64_tr_b16 v[156:157], v209 offset:4096
    ds_read_b64_tr_b16 v[158:159], v209 offset:5120
    v_mfma_f32_32x32x16_bf16 v[112:127], v[132:135], v[140:143], v[112:127]
    s_waitcnt lgkmcnt(0)
    v_mfma_f32_32x32x16_bf16 v[64:79], v[144:147], v[152:155], v[64:79]
    ds_read_b128 v[128:131], v206 offset:0
    ds_read_b128 v[132:135], v206 offset:4096
    v_mfma_f32_32x32x16_bf16 v[80:95], v[144:147], v[156:159], v[80:95]
    ds_read_b64_tr_b16 v[136:137], v208 offset:8192
    ds_read_b64_tr_b16 v[138:139], v208 offset:9216
    v_mfma_f32_32x32x16_bf16 v[96:111], v[148:151], v[152:155], v[96:111]
    ds_read_b64_tr_b16 v[140:141], v209 offset:8192
    ds_read_b64_tr_b16 v[142:143], v209 offset:9216
    v_mfma_f32_32x32x16_bf16 v[112:127], v[148:151], v[156:159], v[112:127]
    s_waitcnt lgkmcnt(0)
    v_mfma_f32_32x32x16_bf16 v[64:79], v[128:131], v[136:139], v[64:79]
    ds_read_b128 v[144:147], v207 offset:0
    ds_read_b128 v[148:151], v207 offset:4096
    v_mfma_f32_32x32x16_bf16 v[80:95], v[128:131], v[140:143], v[80:95]
    ds_read_b64_tr_b16 v[152:153], v208 offset:12288
    ds_read_b64_tr_b16 v[154:155], v208 offset:13312
    v_mfma_f32_32x32x16_bf16 v[96:111], v[132:135], v[136:139], v[96:111]
    ds_read_b64_tr_b16 v[156:157], v209 offset:12288
    ds_read_b64_tr_b16 v[158:159], v209 offset:13312
    v_mfma_f32_32x32x16_bf16 v[112:127], v[132:135], v[140:143], v[112:127]
    s_waitcnt lgkmcnt(0)
    v_mfma_f32_32x32x16_bf16 v[64:79], v[144:147], v[152:155], v[64:79]
    v_mfma_f32_32x32x16_bf16 v[80:95], v[144:147], v[156:159], v[80:95]
    v_mfma_f32_32x32x16_bf16 v[96:111], v[148:151], v[152:155], v[96:111]
    v_mfma_f32_32x32x16_bf16 v[112:127], v[148:151], v[156:159], v[112:127]
    s_nop 15
    s_nop 3
    v_and_b32 v3, 31, v1
    v_lshrrev_b32 v4, 5, v1
    s_sub_u32 s41, s32, 10
    s_lshl_b32 s46, s41, 7
    s_lshl_b32 s47, s35, 6
    s_add_u32 s46, s46, s47
    s_lshl_b32 s45, s31, 11
    s_lshl_b32 s47, s29, 3
    s_add_u32 s45, s45, s47
    s_lshl_b32 s47, s34, 1
    s_add_u32 s45, s45, s47
    s_movk_i32 s48, 3072
    v_mov_b32 v20, 0x3f803f80
    v_mov_b32 v21, 0x3f803f80
    v_mov_b32 v22, 0x3f803f80
    v_mov_b32 v23, 0x3f803f80
    v_add_u32 v5, s46, v3
    v_mul_u32_u24 v7, 3277, v5
    v_lshrrev_b32 v7, 16, v7
    v_mul_u32_u24 v9, 20, v7
    v_sub_u32 v8, v5, v9
    v_lshlrev_b32 v9, 6, v7
    v_add_u32 v9, s45, v9
    v_mul_u32_u24 v10, 3072, v9
    v_lshl_add_u32 v11, v4, 5, v8
    v_lshl_add_u32 v10, v11, 4, v10
    v_add_u32 v10, 1024, v10
    v_add_u32 v12, 320, v10
    v_mov_b32 v13, 0x7ffffff0
    v_cmp_eq_u32 vcc, 0, v8
    s_nop 1
    v_cndmask_b32 v12, v13, v12, vcc
    v_cvt_pk_bf16_f32 v16, v64, v65
    v_cvt_pk_bf16_f32 v17, v66, v67
    v_cvt_pk_bf16_f32 v18, v68, v69
    v_cvt_pk_bf16_f32 v19, v70, v71
    buffer_store_dwordx4 v[16:19], v10, s[20:23], 0 offen offset:0
    buffer_store_dwordx4 v[20:23], v12, s[20:23], 0 offen offset:0
    s_nop 1
    v_cvt_pk_bf16_f32 v16, v72, v73
    v_cvt_pk_bf16_f32 v17, v74, v75
    v_cvt_pk_bf16_f32 v18, v76, v77
    v_cvt_pk_bf16_f32 v19, v78, v79
    buffer_store_dwordx4 v[16:19], v10, s[20:23], 0 offen offset:1024
    buffer_store_dwordx4 v[20:23], v12, s[20:23], 0 offen offset:1024
    s_nop 1
    v_cvt_pk_bf16_f32 v16, v96, v97
    v_cvt_pk_bf16_f32 v17, v98, v99
    v_cvt_pk_bf16_f32 v18, v100, v101
    v_cvt_pk_bf16_f32 v19, v102, v103
    buffer_store_dwordx4 v[16:19], v10, s[20:23], s48 offen offset:0
    buffer_store_dwordx4 v[20:23], v12, s[20:23], s48 offen offset:0
    s_nop 1
    v_cvt_pk_bf16_f32 v16, v104, v105
    v_cvt_pk_bf16_f32 v17, v106, v107
    v_cvt_pk_bf16_f32 v18, v108, v109
    v_cvt_pk_bf16_f32 v19, v110, v111
    buffer_store_dwordx4 v[16:19], v10, s[20:23], s48 offen offset:1024
    buffer_store_dwordx4 v[20:23], v12, s[20:23], s48 offen offset:1024
    s_nop 1
    v_add_u32 v5, s46, v3
    v_add_u32 v5, 32, v5
    v_mul_u32_u24 v7, 3277, v5
    v_lshrrev_b32 v7, 16, v7
    v_mul_u32_u24 v9, 20, v7
    v_sub_u32 v8, v5, v9
    v_lshlrev_b32 v9, 6, v7
    v_add_u32 v9, s45, v9
    v_mul_u32_u24 v10, 3072, v9
    v_lshl_add_u32 v11, v4, 5, v8
    v_lshl_add_u32 v10, v11, 4, v10
    v_add_u32 v10, 1024, v10
    v_add_u32 v12, 320, v10
    v_mov_b32 v13, 0x7ffffff0
    v_cmp_eq_u32 vcc, 0, v8
    s_nop 1
    v_cndmask_b32 v12, v13, v12, vcc
    v_cvt_pk_bf16_f32 v16, v80, v81
    v_cvt_pk_bf16_f32 v17, v82, v83
    v_cvt_pk_bf16_f32 v18, v84, v85
    v_cvt_pk_bf16_f32 v19, v86, v87
    buffer_store_dwordx4 v[16:19], v10, s[20:23], 0 offen offset:0
    buffer_store_dwordx4 v[20:23], v12, s[20:23], 0 offen offset:0
    s_nop 1
    v_cvt_pk_bf16_f32 v16, v88, v89
    v_cvt_pk_bf16_f32 v17, v90, v91
    v_cvt_pk_bf16_f32 v18, v92, v93
    v_cvt_pk_bf16_f32 v19, v94, v95
    buffer_store_dwordx4 v[16:19], v10, s[20:23], 0 offen offset:1024
    buffer_store_dwordx4 v[20:23], v12, s[20:23], 0 offen offset:1024
    s_nop 1
    v_cvt_pk_bf16_f32 v16, v112, v113
    v_cvt_pk_bf16_f32 v17, v114, v115
    v_cvt_pk_bf16_f32 v18, v116, v117
    v_cvt_pk_bf16_f32 v19, v118, v119
    buffer_store_dwordx4 v[16:19], v10, s[20:23], s48 offen offset:0
    buffer_store_dwordx4 v[20:23], v12, s[20:23], s48 offen offset:0
    s_nop 1
    v_cvt_pk_bf16_f32 v16, v120, v121
    v_cvt_pk_bf16_f32 v17, v122, v123
    v_cvt_pk_bf16_f32 v18, v124, v125
    v_cvt_pk_bf16_f32 v19, v126, v127
    buffer_store_dwordx4 v[16:19], v10, s[20:23], s48 offen offset:1024
    buffer_store_dwordx4 v[20:23], v12, s[20:23], s48 offen offset:1024
    s_nop 1
    s_waitcnt vmcnt(0)
    s_branch K1_END
K1_GATE:
    s_mov_b32 s12, s4
    s_and_b32 s13, s5, 0xffff
    s_mov_b32 s14, 0x280000
    s_mov_b32 s15, 0x00020000
    s_mov_b32 s16, s24
    s_and_b32 s17, s25, 0xffff
    s_mov_b32 s18, 0x500
    s_mov_b32 s19, 0x00020000
    s_lshl_b32 s29, s39, 7
    s_lshl_b32 s30, s28, 4
    s_add_u32 s29, s29, s30
    v_lshlrev_b32 v3, 2, v1
    buffer_load_dword v10, v3, s[16:19], 0 offen offset:0
    buffer_load_dword v11, v3, s[16:19], 0 offen offset:256
    buffer_load_dword v12, v3, s[16:19], 0 offen offset:512
    buffer_load_dword v13, v3, s[16:19], 0 offen offset:768
    buffer_load_dword v14, v3, s[16:19], 0 offen offset:1024
    s_mul_i32 s30, s29, 1280
    buffer_load_dword v32, v3, s[12:15], s30 offen offset:0
    buffer_load_dword v33, v3, s[12:15], s30 offen offset:256
    buffer_load_dword v34, v3, s[12:15], s30 offen offset:512
    buffer_load_dword v35, v3, s[12:15], s30 offen offset:768
    buffer_load_dword v36, v3, s[12:15], s30 offen offset:1024
    s_add_u32 s30, s30, 1280
    buffer_load_dword v37, v3, s[12:15], s30 offen offset:0
    buffer_load_dword v38, v3, s[12:15], s30 offen offset:256
    buffer_load_dword v39, v3, s[12:15], s30 offen offset:512
    buffer_load_dword v40, v3, s[12:15], s30 offen offset:768
    buffer_load_dword v41, v3, s[12:15], s30 offen offset:1024
    s_add_u32 s30, s30, 1280
    buffer_load_dword v42, v3, s[12:15], s30 offen offset:0
    buffer_load_dword v43, v3, s[12:15], s30 offen offset:256
    buffer_load_dword v44, v3, s[12:15], s30 offen offset:512
    buffer_load_dword v45, v3, s[12:15], s30 offen offset:768
    buffer_load_dword v46, v3, s[12:15], s30 offen offset:1024
    s_add_u32 s30, s30, 1280
    buffer_load_dword v47, v3, s[12:15], s30 offen offset:0
    buffer_load_dword v48, v3, s[12:15], s30 offen offset:256
    buffer_load_dword v49, v3, s[12:15], s30 offen offset:512
    buffer_load_dword v50, v3, s[12:15], s30 offen offset:768
    buffer_load_dword v51, v3, s[12:15], s30 offen offset:1024
    s_add_u32 s30, s30, 1280
    buffer_load_dword v52, v3, s[12:15], s30 offen offset:0
    buffer_load_dword v53, v3, s[12:15], s30 offen offset:256
    buffer_load_dword v54, v3, s[12:15], s30 offen offset:512
    buffer_load_dword v55, v3, s[12:15], s30 offen offset:768
    buffer_load_dword v56, v3, s[12:15], s30 offen offset:1024
    s_add_u32 s30, s30, 1280
    buffer_load_dword v57, v3, s[12:15], s30 offen offset:0
    buffer_load_dword v58, v3, s[12:15], s30 offen offset:256
    buffer_load_dword v59, v3, s[12:15], s30 offen offset:512
    buffer_load_dword v60, v3, s[12:15], s30 offen offset:768
    buffer_load_dword v61, v3, s[12:15], s30 offen offset:1024
    s_add_u32 s30, s30, 1280
    buffer_load_dword v62, v3, s[12:15], s30 offen offset:0
    buffer_load_dword v63, v3, s[12:15], s30 offen offset:256
    buffer_load_dword v64, v3, s[12:15], s30 offen offset:512
    buffer_load_dword v65, v3, s[12:15], s30 offen offset:768
    buffer_load_dword v66, v3, s[12:15], s30 offen offset:1024
    s_add_u32 s30, s30, 1280
    buffer_load_dword v67, v3, s[12:15], s30 offen offset:0
    buffer_load_dword v68, v3, s[12:15], s30 offen offset:256
    buffer_load_dword v69, v3, s[12:15], s30 offen offset:512
    buffer_load_dword v70, v3, s[12:15], s30 offen offset:768
    buffer_load_dword v71, v3, s[12:15], s30 offen offset:1024
    s_add_u32 s30, s30, 1280
    buffer_load_dword v72, v3, s[12:15], s30 offen offset:0
    buffer_load_dword v73, v3, s[12:15], s30 offen offset:256
    buffer_load_dword v74, v3, s[12:15], s30 offen offset:512
    buffer_load_dword v75, v3, s[12:15], s30 offen offset:768
    buffer_load_dword v76, v3, s[12:15], s30 offen offset:1024
    s_add_u32 s30, s30, 1280
    buffer_load_dword v77, v3, s[12:15], s30 offen offset:0
    buffer_load_dword v78, v3, s[12:15], s30 offen offset:256
    buffer_load_dword v79, v3, s[12:15], s30 offen offset:512
    buffer_load_dword v80, v3, s[12:15], s30 offen offset:768
    buffer_load_dword v81, v3, s[12:15], s30 offen offset:1024
    s_add_u32 s30, s30, 1280
    buffer_load_dword v82, v3, s[12:15], s30 offen offset:0
    buffer_load_dword v83, v3, s[12:15], s30 offen offset:256
    buffer_load_dword v84, v3, s[12:15], s30 offen offset:512
    buffer_load_dword v85, v3, s[12:15], s30 offen offset:768
    buffer_load_dword v86, v3, s[12:15], s30 offen offset:1024
    s_add_u32 s30, s30, 1280
    buffer_load_dword v87, v3, s[12:15], s30 offen offset:0
    buffer_load_dword v88, v3, s[12:15], s30 offen offset:256
    buffer_load_dword v89, v3, s[12:15], s30 offen offset:512
    buffer_load_dword v90, v3, s[12:15], s30 offen offset:768
    buffer_load_dword v91, v3, s[12:15], s30 offen offset:1024
    s_add_u32 s30, s30, 1280
    buffer_load_dword v92, v3, s[12:15], s30 offen offset:0
    buffer_load_dword v93, v3, s[12:15], s30 offen offset:256
    buffer_load_dword v94, v3, s[12:15], s30 offen offset:512
    buffer_load_dword v95, v3, s[12:15], s30 offen offset:768
    buffer_load_dword v96, v3, s[12:15], s30 offen offset:1024
    s_add_u32 s30, s30, 1280
    buffer_load_dword v97, v3, s[12:15], s30 offen offset:0
    buffer_load_dword v98, v3, s[12:15], s30 offen offset:256
    buffer_load_dword v99, v3, s[12:15], s30 offen offset:512
    buffer_load_dword v100, v3, s[12:15], s30 offen offset:768
    buffer_load_dword v101, v3, s[12:15], s30 offen offset:1024
    s_add_u32 s30, s30, 1280
    buffer_load_dword v102, v3, s[12:15], s30 offen offset:0
    buffer_load_dword v103, v3, s[12:15], s30 offen offset:256
    buffer_load_dword v104, v3, s[12:15], s30 offen offset:512
    buffer_load_dword v105, v3, s[12:15], s30 offen offset:768
    buffer_load_dword v106, v3, s[12:15], s30 offen offset:1024
    s_add_u32 s30, s30, 1280
    buffer_load_dword v107, v3, s[12:15], s30 offen offset:0
    buffer_load_dword v108, v3, s[12:15], s30 offen offset:256
    buffer_load_dword v109, v3, s[12:15], s30 offen offset:512
    buffer_load_dword v110, v3, s[12:15], s30 offen offset:768
    buffer_load_dword v111, v3, s[12:15], s30 offen offset:1024
    s_waitcnt vmcnt(0)
    v_lshlrev_b32 v16, 16, v10
    v_and_b32 v17, 0xffff0000, v10
    v_lshlrev_b32 v18, 16, v11
    v_and_b32 v19, 0xffff0000, v11
    v_lshlrev_b32 v20, 16, v12
    v_and_b32 v21, 0xffff0000, v12
    v_lshlrev_b32 v22, 16, v13
    v_and_b32 v23, 0xffff0000, v13
    v_lshlrev_b32 v24, 16, v14
    v_and_b32 v25, 0xffff0000, v14
    v_lshlrev_b32 v4, 16, v32
    v_and_b32 v5, 0xffff0000, v32
    v_mul_f32 v112, v4, v16
    v_fmac_f32 v112, v5, v17
    v_lshlrev_b32 v4, 16, v33
    v_and_b32 v5, 0xffff0000, v33
    v_fmac_f32 v112, v4, v18
    v_fmac_f32 v112, v5, v19
    v_lshlrev_b32 v4, 16, v34
    v_and_b32 v5, 0xffff0000, v34
    v_fmac_f32 v112, v4, v20
    v_fmac_f32 v112, v5, v21
    v_lshlrev_b32 v4, 16, v35
    v_and_b32 v5, 0xffff0000, v35
    v_fmac_f32 v112, v4, v22
    v_fmac_f32 v112, v5, v23
    v_lshlrev_b32 v4, 16, v36
    v_and_b32 v5, 0xffff0000, v36
    v_fmac_f32 v112, v4, v24
    v_fmac_f32 v112, v5, v25
    v_lshlrev_b32 v4, 16, v37
    v_and_b32 v5, 0xffff0000, v37
    v_mul_f32 v113, v4, v16
    v_fmac_f32 v113, v5, v17
    v_lshlrev_b32 v4, 16, v38
    v_and_b32 v5, 0xffff0000, v38
    v_fmac_f32 v113, v4, v18
    v_fmac_f32 v113, v5, v19
    v_lshlrev_b32 v4, 16, v39
    v_and_b32 v5, 0xffff0000, v39
    v_fmac_f32 v113, v4, v20
    v_fmac_f32 v113, v5, v21
    v_lshlrev_b32 v4, 16, v40
    v_and_b32 v5, 0xffff0000, v40
    v_fmac_f32 v113, v4, v22
    v_fmac_f32 v113, v5, v23
    v_lshlrev_b32 v4, 16, v41
    v_and_b32 v5, 0xffff0000, v41
    v_fmac_f32 v113, v4, v24
    v_fmac_f32 v113, v5, v25
    v_lshlrev_b32 v4, 16, v42
    v_and_b32 v5, 0xffff0000, v42
    v_mul_f32 v114, v4, v16
    v_fmac_f32 v114, v5, v17
    v_lshlrev_b32 v4, 16, v43
    v_and_b32 v5, 0xffff0000, v43
    v_fmac_f32 v114, v4, v18
    v_fmac_f32 v114, v5, v19
    v_lshlrev_b32 v4, 16, v44
    v_and_b32 v5, 0xffff0000, v44
    v_fmac_f32 v114, v4, v20
    v_fmac_f32 v114, v5, v21
    v_lshlrev_b32 v4, 16, v45
    v_and_b32 v5, 0xffff0000, v45
    v_fmac_f32 v114, v4, v22
    v_fmac_f32 v114, v5, v23
    v_lshlrev_b32 v4, 16, v46
    v_and_b32 v5, 0xffff0000, v46
    v_fmac_f32 v114, v4, v24
    v_fmac_f32 v114, v5, v25
    v_lshlrev_b32 v4, 16, v47
    v_and_b32 v5, 0xffff0000, v47
    v_mul_f32 v115, v4, v16
    v_fmac_f32 v115, v5, v17
    v_lshlrev_b32 v4, 16, v48
    v_and_b32 v5, 0xffff0000, v48
    v_fmac_f32 v115, v4, v18
    v_fmac_f32 v115, v5, v19
    v_lshlrev_b32 v4, 16, v49
    v_and_b32 v5, 0xffff0000, v49
    v_fmac_f32 v115, v4, v20
    v_fmac_f32 v115, v5, v21
    v_lshlrev_b32 v4, 16, v50
    v_and_b32 v5, 0xffff0000, v50
    v_fmac_f32 v115, v4, v22
    v_fmac_f32 v115, v5, v23
    v_lshlrev_b32 v4, 16, v51
    v_and_b32 v5, 0xffff0000, v51
    v_fmac_f32 v115, v4, v24
    v_fmac_f32 v115, v5, v25
    v_lshlrev_b32 v4, 16, v52
    v_and_b32 v5, 0xffff0000, v52
    v_mul_f32 v116, v4, v16
    v_fmac_f32 v116, v5, v17
    v_lshlrev_b32 v4, 16, v53
    v_and_b32 v5, 0xffff0000, v53
    v_fmac_f32 v116, v4, v18
    v_fmac_f32 v116, v5, v19
    v_lshlrev_b32 v4, 16, v54
    v_and_b32 v5, 0xffff0000, v54
    v_fmac_f32 v116, v4, v20
    v_fmac_f32 v116, v5, v21
    v_lshlrev_b32 v4, 16, v55
    v_and_b32 v5, 0xffff0000, v55
    v_fmac_f32 v116, v4, v22
    v_fmac_f32 v116, v5, v23
    v_lshlrev_b32 v4, 16, v56
    v_and_b32 v5, 0xffff0000, v56
    v_fmac_f32 v116, v4, v24
    v_fmac_f32 v116, v5, v25
    v_lshlrev_b32 v4, 16, v57
    v_and_b32 v5, 0xffff0000, v57
    v_mul_f32 v117, v4, v16
    v_fmac_f32 v117, v5, v17
    v_lshlrev_b32 v4, 16, v58
    v_and_b32 v5, 0xffff0000, v58
    v_fmac_f32 v117, v4, v18
    v_fmac_f32 v117, v5, v19
    v_lshlrev_b32 v4, 16, v59
    v_and_b32 v5, 0xffff0000, v59
    v_fmac_f32 v117, v4, v20
    v_fmac_f32 v117, v5, v21
    v_lshlrev_b32 v4, 16, v60
    v_and_b32 v5, 0xffff0000, v60
    v_fmac_f32 v117, v4, v22
    v_fmac_f32 v117, v5, v23
    v_lshlrev_b32 v4, 16, v61
    v_and_b32 v5, 0xffff0000, v61
    v_fmac_f32 v117, v4, v24
    v_fmac_f32 v117, v5, v25
    v_lshlrev_b32 v4, 16, v62
    v_and_b32 v5, 0xffff0000, v62
    v_mul_f32 v118, v4, v16
    v_fmac_f32 v118, v5, v17
    v_lshlrev_b32 v4, 16, v63
    v_and_b32 v5, 0xffff0000, v63
    v_fmac_f32 v118, v4, v18
    v_fmac_f32 v118, v5, v19
    v_lshlrev_b32 v4, 16, v64
    v_and_b32 v5, 0xffff0000, v64
    v_fmac_f32 v118, v4, v20
    v_fmac_f32 v118, v5, v21
    v_lshlrev_b32 v4, 16, v65
    v_and_b32 v5, 0xffff0000, v65
    v_fmac_f32 v118, v4, v22
    v_fmac_f32 v118, v5, v23
    v_lshlrev_b32 v4, 16, v66
    v_and_b32 v5, 0xffff0000, v66
    v_fmac_f32 v118, v4, v24
    v_fmac_f32 v118, v5, v25
    v_lshlrev_b32 v4, 16, v67
    v_and_b32 v5, 0xffff0000, v67
    v_mul_f32 v119, v4, v16
    v_fmac_f32 v119, v5, v17
    v_lshlrev_b32 v4, 16, v68
    v_and_b32 v5, 0xffff0000, v68
    v_fmac_f32 v119, v4, v18
    v_fmac_f32 v119, v5, v19
    v_lshlrev_b32 v4, 16, v69
    v_and_b32 v5, 0xffff0000, v69
    v_fmac_f32 v119, v4, v20
    v_fmac_f32 v119, v5, v21
    v_lshlrev_b32 v4, 16, v70
    v_and_b32 v5, 0xffff0000, v70
    v_fmac_f32 v119, v4, v22
    v_fmac_f32 v119, v5, v23
    v_lshlrev_b32 v4, 16, v71
    v_and_b32 v5, 0xffff0000, v71
    v_fmac_f32 v119, v4, v24
    v_fmac_f32 v119, v5, v25
    v_lshlrev_b32 v4, 16, v72
    v_and_b32 v5, 0xffff0000, v72
    v_mul_f32 v120, v4, v16
    v_fmac_f32 v120, v5, v17
    v_lshlrev_b32 v4, 16, v73
    v_and_b32 v5, 0xffff0000, v73
    v_fmac_f32 v120, v4, v18
    v_fmac_f32 v120, v5, v19
    v_lshlrev_b32 v4, 16, v74
    v_and_b32 v5, 0xffff0000, v74
    v_fmac_f32 v120, v4, v20
    v_fmac_f32 v120, v5, v21
    v_lshlrev_b32 v4, 16, v75
    v_and_b32 v5, 0xffff0000, v75
    v_fmac_f32 v120, v4, v22
    v_fmac_f32 v120, v5, v23
    v_lshlrev_b32 v4, 16, v76
    v_and_b32 v5, 0xffff0000, v76
    v_fmac_f32 v120, v4, v24
    v_fmac_f32 v120, v5, v25
    v_lshlrev_b32 v4, 16, v77
    v_and_b32 v5, 0xffff0000, v77
    v_mul_f32 v121, v4, v16
    v_fmac_f32 v121, v5, v17
    v_lshlrev_b32 v4, 16, v78
    v_and_b32 v5, 0xffff0000, v78
    v_fmac_f32 v121, v4, v18
    v_fmac_f32 v121, v5, v19
    v_lshlrev_b32 v4, 16, v79
    v_and_b32 v5, 0xffff0000, v79
    v_fmac_f32 v121, v4, v20
    v_fmac_f32 v121, v5, v21
    v_lshlrev_b32 v4, 16, v80
    v_and_b32 v5, 0xffff0000, v80
    v_fmac_f32 v121, v4, v22
    v_fmac_f32 v121, v5, v23
    v_lshlrev_b32 v4, 16, v81
    v_and_b32 v5, 0xffff0000, v81
    v_fmac_f32 v121, v4, v24
    v_fmac_f32 v121, v5, v25
    v_lshlrev_b32 v4, 16, v82
    v_and_b32 v5, 0xffff0000, v82
    v_mul_f32 v122, v4, v16
    v_fmac_f32 v122, v5, v17
    v_lshlrev_b32 v4, 16, v83
    v_and_b32 v5, 0xffff0000, v83
    v_fmac_f32 v122, v4, v18
    v_fmac_f32 v122, v5, v19
    v_lshlrev_b32 v4, 16, v84
    v_and_b32 v5, 0xffff0000, v84
    v_fmac_f32 v122, v4, v20
    v_fmac_f32 v122, v5, v21
    v_lshlrev_b32 v4, 16, v85
    v_and_b32 v5, 0xffff0000, v85
    v_fmac_f32 v122, v4, v22
    v_fmac_f32 v122, v5, v23
    v_lshlrev_b32 v4, 16, v86
    v_and_b32 v5, 0xffff0000, v86
    v_fmac_f32 v122, v4, v24
    v_fmac_f32 v122, v5, v25
    v_lshlrev_b32 v4, 16, v87
    v_and_b32 v5, 0xffff0000, v87
    v_mul_f32 v123, v4, v16
    v_fmac_f32 v123, v5, v17
    v_lshlrev_b32 v4, 16, v88
    v_and_b32 v5, 0xffff0000, v88
    v_fmac_f32 v123, v4, v18
    v_fmac_f32 v123, v5, v19
    v_lshlrev_b32 v4, 16, v89
    v_and_b32 v5, 0xffff0000, v89
    v_fmac_f32 v123, v4, v20
    v_fmac_f32 v123, v5, v21
    v_lshlrev_b32 v4, 16, v90
    v_and_b32 v5, 0xffff0000, v90
    v_fmac_f32 v123, v4, v22
    v_fmac_f32 v123, v5, v23
    v_lshlrev_b32 v4, 16, v91
    v_and_b32 v5, 0xffff0000, v91
    v_fmac_f32 v123, v4, v24
    v_fmac_f32 v123, v5, v25
    v_lshlrev_b32 v4, 16, v92
    v_and_b32 v5, 0xffff0000, v92
    v_mul_f32 v124, v4, v16
    v_fmac_f32 v124, v5, v17
    v_lshlrev_b32 v4, 16, v93
    v_and_b32 v5, 0xffff0000, v93
    v_fmac_f32 v124, v4, v18
    v_fmac_f32 v124, v5, v19
    v_lshlrev_b32 v4, 16, v94
    v_and_b32 v5, 0xffff0000, v94
    v_fmac_f32 v124, v4, v20
    v_fmac_f32 v124, v5, v21
    v_lshlrev_b32 v4, 16, v95
    v_and_b32 v5, 0xffff0000, v95
    v_fmac_f32 v124, v4, v22
    v_fmac_f32 v124, v5, v23
    v_lshlrev_b32 v4, 16, v96
    v_and_b32 v5, 0xffff0000, v96
    v_fmac_f32 v124, v4, v24
    v_fmac_f32 v124, v5, v25
    v_lshlrev_b32 v4, 16, v97
    v_and_b32 v5, 0xffff0000, v97
    v_mul_f32 v125, v4, v16
    v_fmac_f32 v125, v5, v17
    v_lshlrev_b32 v4, 16, v98
    v_and_b32 v5, 0xffff0000, v98
    v_fmac_f32 v125, v4, v18
    v_fmac_f32 v125, v5, v19
    v_lshlrev_b32 v4, 16, v99
    v_and_b32 v5, 0xffff0000, v99
    v_fmac_f32 v125, v4, v20
    v_fmac_f32 v125, v5, v21
    v_lshlrev_b32 v4, 16, v100
    v_and_b32 v5, 0xffff0000, v100
    v_fmac_f32 v125, v4, v22
    v_fmac_f32 v125, v5, v23
    v_lshlrev_b32 v4, 16, v101
    v_and_b32 v5, 0xffff0000, v101
    v_fmac_f32 v125, v4, v24
    v_fmac_f32 v125, v5, v25
    v_lshlrev_b32 v4, 16, v102
    v_and_b32 v5, 0xffff0000, v102
    v_mul_f32 v126, v4, v16
    v_fmac_f32 v126, v5, v17
    v_lshlrev_b32 v4, 16, v103
    v_and_b32 v5, 0xffff0000, v103
    v_fmac_f32 v126, v4, v18
    v_fmac_f32 v126, v5, v19
    v_lshlrev_b32 v4, 16, v104
    v_and_b32 v5, 0xffff0000, v104
    v_fmac_f32 v126, v4, v20
    v_fmac_f32 v126, v5, v21
    v_lshlrev_b32 v4, 16, v105
    v_and_b32 v5, 0xffff0000, v105
    v_fmac_f32 v126, v4, v22
    v_fmac_f32 v126, v5, v23
    v_lshlrev_b32 v4, 16, v106
    v_and_b32 v5, 0xffff0000, v106
    v_fmac_f32 v126, v4, v24
    v_fmac_f32 v126, v5, v25
    v_lshlrev_b32 v4, 16, v107
    v_and_b32 v5, 0xffff0000, v107
    v_mul_f32 v127, v4, v16
    v_fmac_f32 v127, v5, v17
    v_lshlrev_b32 v4, 16, v108
    v_and_b32 v5, 0xffff0000, v108
    v_fmac_f32 v127, v4, v18
    v_fmac_f32 v127, v5, v19
    v_lshlrev_b32 v4, 16, v109
    v_and_b32 v5, 0xffff0000, v109
    v_fmac_f32 v127, v4, v20
    v_fmac_f32 v127, v5, v21
    v_lshlrev_b32 v4, 16, v110
    v_and_b32 v5, 0xffff0000, v110
    v_fmac_f32 v127, v4, v22
    v_fmac_f32 v127, v5, v23
    v_lshlrev_b32 v4, 16, v111
    v_and_b32 v5, 0xffff0000, v111
    v_fmac_f32 v127, v4, v24
    v_fmac_f32 v127, v5, v25
    ds_swizzle_b32 v128, v112 offset:0x41f
    ds_swizzle_b32 v129, v113 offset:0x41f
    ds_swizzle_b32 v130, v114 offset:0x41f
    ds_swizzle_b32 v131, v115 offset:0x41f
    ds_swizzle_b32 v132, v116 offset:0x41f
    ds_swizzle_b32 v133, v117 offset:0x41f
    ds_swizzle_b32 v134, v118 offset:0x41f
    ds_swizzle_b32 v135, v119 offset:0x41f
    ds_swizzle_b32 v136, v120 offset:0x41f
    ds_swizzle_b32 v137, v121 offset:0x41f
    ds_swizzle_b32 v138, v122 offset:0x41f
    ds_swizzle_b32 v139, v123 offset:0x41f
    ds_swizzle_b32 v140, v124 offset:0x41f
    ds_swizzle_b32 v141, v125 offset:0x41f
    ds_swizzle_b32 v142, v126 offset:0x41f
    ds_swizzle_b32 v143, v127 offset:0x41f
    s_waitcnt lgkmcnt(0)
    v_add_f32 v112, v112, v128
    v_add_f32 v113, v113, v129
    v_add_f32 v114, v114, v130
    v_add_f32 v115, v115, v131
    v_add_f32 v116, v116, v132
    v_add_f32 v117, v117, v133
    v_add_f32 v118, v118, v134
    v_add_f32 v119, v119, v135
    v_add_f32 v120, v120, v136
    v_add_f32 v121, v121, v137
    v_add_f32 v122, v122, v138
    v_add_f32 v123, v123, v139
    v_add_f32 v124, v124, v140
    v_add_f32 v125, v125, v141
    v_add_f32 v126, v126, v142
    v_add_f32 v127, v127, v143
    ds_swizzle_b32 v128, v112 offset:0x81f
    ds_swizzle_b32 v129, v113 offset:0x81f
    ds_swizzle_b32 v130, v114 offset:0x81f
    ds_swizzle_b32 v131, v115 offset:0x81f
    ds_swizzle_b32 v132, v116 offset:0x81f
    ds_swizzle_b32 v133, v117 offset:0x81f
    ds_swizzle_b32 v134, v118 offset:0x81f
    ds_swizzle_b32 v135, v119 offset:0x81f
    ds_swizzle_b32 v136, v120 offset:0x81f
    ds_swizzle_b32 v137, v121 offset:0x81f
    ds_swizzle_b32 v138, v122 offset:0x81f
    ds_swizzle_b32 v139, v123 offset:0x81f
    ds_swizzle_b32 v140, v124 offset:0x81f
    ds_swizzle_b32 v141, v125 offset:0x81f
    ds_swizzle_b32 v142, v126 offset:0x81f
    ds_swizzle_b32 v143, v127 offset:0x81f
    s_waitcnt lgkmcnt(0)
    v_add_f32 v112, v112, v128
    v_add_f32 v113, v113, v129
    v_add_f32 v114, v114, v130
    v_add_f32 v115, v115, v131
    v_add_f32 v116, v116, v132
    v_add_f32 v117, v117, v133
    v_add_f32 v118, v118, v134
    v_add_f32 v119, v119, v135
    v_add_f32 v120, v120, v136
    v_add_f32 v121, v121, v137
    v_add_f32 v122, v122, v138
    v_add_f32 v123, v123, v139
    v_add_f32 v124, v124, v140
    v_add_f32 v125, v125, v141
    v_add_f32 v126, v126, v142
    v_add_f32 v127, v127, v143
    ds_swizzle_b32 v128, v112 offset:0x101f
    ds_swizzle_b32 v129, v113 offset:0x101f
    ds_swizzle_b32 v130, v114 offset:0x101f
    ds_swizzle_b32 v131, v115 offset:0x101f
    ds_swizzle_b32 v132, v116 offset:0x101f
    ds_swizzle_b32 v133, v117 offset:0x101f
    ds_swizzle_b32 v134, v118 offset:0x101f
    ds_swizzle_b32 v135, v119 offset:0x101f
    ds_swizzle_b32 v136, v120 offset:0x101f
    ds_swizzle_b32 v137, v121 offset:0x101f
    ds_swizzle_b32 v138, v122 offset:0x101f
    ds_swizzle_b32 v139, v123 offset:0x101f
    ds_swizzle_b32 v140, v124 offset:0x101f
    ds_swizzle_b32 v141, v125 offset:0x101f
    ds_swizzle_b32 v142, v126 offset:0x101f
    ds_swizzle_b32 v143, v127 offset:0x101f
    s_waitcnt lgkmcnt(0)
    v_add_f32 v112, v112, v128
    v_add_f32 v113, v113, v129
    v_add_f32 v114, v114, v130
    v_add_f32 v115, v115, v131
    v_add_f32 v116, v116, v132
    v_add_f32 v117, v117, v133
    v_add_f32 v118, v118, v134
    v_add_f32 v119, v119, v135
    v_add_f32 v120, v120, v136
    v_add_f32 v121, v121, v137
    v_add_f32 v122, v122, v138
    v_add_f32 v123, v123, v139
    v_add_f32 v124, v124, v140
    v_add_f32 v125, v125, v141
    v_add_f32 v126, v126, v142
    v_add_f32 v127, v127, v143
    ds_swizzle_b32 v128, v112 offset:0x201f
    ds_swizzle_b32 v129, v113 offset:0x201f
    ds_swizzle_b32 v130, v114 offset:0x201f
    ds_swizzle_b32 v131, v115 offset:0x201f
    ds_swizzle_b32 v132, v116 offset:0x201f
    ds_swizzle_b32 v133, v117 offset:0x201f
    ds_swizzle_b32 v134, v118 offset:0x201f
    ds_swizzle_b32 v135, v119 offset:0x201f
    ds_swizzle_b32 v136, v120 offset:0x201f
    ds_swizzle_b32 v137, v121 offset:0x201f
    ds_swizzle_b32 v138, v122 offset:0x201f
    ds_swizzle_b32 v139, v123 offset:0x201f
    ds_swizzle_b32 v140, v124 offset:0x201f
    ds_swizzle_b32 v141, v125 offset:0x201f
    ds_swizzle_b32 v142, v126 offset:0x201f
    ds_swizzle_b32 v143, v127 offset:0x201f
    s_waitcnt lgkmcnt(0)
    v_add_f32 v112, v112, v128
    v_add_f32 v113, v113, v129
    v_add_f32 v114, v114, v130
    v_add_f32 v115, v115, v131
    v_add_f32 v116, v116, v132
    v_add_f32 v117, v117, v133
    v_add_f32 v118, v118, v134
    v_add_f32 v119, v119, v135
    v_add_f32 v120, v120, v136
    v_add_f32 v121, v121, v137
    v_add_f32 v122, v122, v138
    v_add_f32 v123, v123, v139
    v_add_f32 v124, v124, v140
    v_add_f32 v125, v125, v141
    v_add_f32 v126, v126, v142
    v_add_f32 v127, v127, v143
    ds_swizzle_b32 v128, v112 offset:0x401f
    ds_swizzle_b32 v129, v113 offset:0x401f
    ds_swizzle_b32 v130, v114 offset:0x401f
    ds_swizzle_b32 v131, v115 offset:0x401f
    ds_swizzle_b32 v132, v116 offset:0x401f
    ds_swizzle_b32 v133, v117 offset:0x401f
    ds_swizzle_b32 v134, v118 offset:0x401f
    ds_swizzle_b32 v135, v119 offset:0x401f
    ds_swizzle_b32 v136, v120 offset:0x401f
    ds_swizzle_b32 v137, v121 offset:0x401f
    ds_swizzle_b32 v138, v122 offset:0x401f
    ds_swizzle_b32 v139, v123 offset:0x401f
    ds_swizzle_b32 v140, v124 offset:0x401f
    ds_swizzle_b32 v141, v125 offset:0x401f
    ds_swizzle_b32 v142, v126 offset:0x401f
    ds_swizzle_b32 v143, v127 offset:0x401f
    s_waitcnt lgkmcnt(0)
    v_add_f32 v112, v112, v128
    v_add_f32 v113, v113, v129
    v_add_f32 v114, v114, v130
    v_add_f32 v115, v115, v131
    v_add_f32 v116, v116, v132
    v_add_f32 v117, v117, v133
    v_add_f32 v118, v118, v134
    v_add_f32 v119, v119, v135
    v_add_f32 v120, v120, v136
    v_add_f32 v121, v121, v137
    v_add_f32 v122, v122, v138
    v_add_f32 v123, v123, v139
    v_add_f32 v124, v124, v140
    v_add_f32 v125, v125, v141
    v_add_f32 v126, v126, v142
    v_add_f32 v127, v127, v143
    v_mov_b32 v128, v112
    v_mov_b32 v129, v113
    v_mov_b32 v130, v114
    v_mov_b32 v131, v115
    v_mov_b32 v132, v116
    v_mov_b32 v133, v117
    v_mov_b32 v134, v118
    v_mov_b32 v135, v119
    v_mov_b32 v136, v120
    v_mov_b32 v137, v121
    v_mov_b32 v138, v122
    v_mov_b32 v139, v123
    v_mov_b32 v140, v124
    v_mov_b32 v141, v125
    v_mov_b32 v142, v126
    v_mov_b32 v143, v127
    s_nop 1
    v_permlane32_swap_b32 v112, v128
    v_permlane32_swap_b32 v113, v129
    v_permlane32_swap_b32 v114, v130
    v_permlane32_swap_b32 v115, v131
    v_permlane32_swap_b32 v116, v132
    v_permlane32_swap_b32 v117, v133
    v_permlane32_swap_b32 v118, v134
    v_permlane32_swap_b32 v119, v135
    v_permlane32_swap_b32 v120, v136
    v_permlane32_swap_b32 v121, v137
    v_permlane32_swap_b32 v122, v138
    v_permlane32_swap_b32 v123, v139
    v_permlane32_swap_b32 v124, v140
    v_permlane32_swap_b32 v125, v141
    v_permlane32_swap_b32 v126, v142
    v_permlane32_swap_b32 v127, v143
    v_add_f32 v112, v112, v128
    v_add_f32 v113, v113, v129
    v_add_f32 v114, v114, v130
    v_add_f32 v115, v115, v131
    v_add_f32 v116, v116, v132
    v_add_f32 v117, v117, v133
    v_add_f32 v118, v118, v134
    v_add_f32 v119, v119, v135
    v_add_f32 v120, v120, v136
    v_add_f32 v121, v121, v137
    v_add_f32 v122, v122, v138
    v_add_f32 v123, v123, v139
    v_add_f32 v124, v124, v140
    v_add_f32 v125, v125, v141
    v_add_f32 v126, v126, v142
    v_add_f32 v127, v127, v143
    v_mov_b32 v4, v112
    v_cmp_eq_u32 vcc, 1, v1
    s_nop 1
    v_cndmask_b32 v4, v4, v113, vcc
    v_cmp_eq_u32 vcc, 2, v1
    s_nop 1
    v_cndmask_b32 v4, v4, v114, vcc
    v_cmp_eq_u32 vcc, 3, v1
    s_nop 1
    v_cndmask_b32 v4, v4, v115, vcc
    v_cmp_eq_u32 vcc, 4, v1
    s_nop 1
    v_cndmask_b32 v4, v4, v116, vcc
    v_cmp_eq_u32 vcc, 5, v1
    s_nop 1
    v_cndmask_b32 v4, v4, v117, vcc
    v_cmp_eq_u32 vcc, 6, v1
    s_nop 1
    v_cndmask_b32 v4, v4, v118, vcc
    v_cmp_eq_u32 vcc, 7, v1
    s_nop 1
    v_cndmask_b32 v4, v4, v119, vcc
    v_cmp_eq_u32 vcc, 8, v1
    s_nop 1
    v_cndmask_b32 v4, v4, v120, vcc
    v_cmp_eq_u32 vcc, 9, v1
    s_nop 1
    v_cndmask_b32 v4, v4, v121, vcc
    v_cmp_eq_u32 vcc, 10, v1
    s_nop 1
    v_cndmask_b32 v4, v4, v122, vcc
    v_cmp_eq_u32 vcc, 11, v1
    s_nop 1
    v_cndmask_b32 v4, v4, v123, vcc
    v_cmp_eq_u32 vcc, 12, v1
    s_nop 1
    v_cndmask_b32 v4, v4, v124, vcc
    v_cmp_eq_u32 vcc, 13, v1
    s_nop 1
    v_cndmask_b32 v4, v4, v125, vcc
    v_cmp_eq_u32 vcc, 14, v1
    s_nop 1
    v_cndmask_b32 v4, v4, v126, vcc
    v_cmp_eq_u32 vcc, 15, v1
    s_nop 1
    v_cndmask_b32 v4, v4, v127, vcc
    v_mul_f32 v4, 0xbfb8aa3b, v4
    v_exp_f32 v4, v4
    s_nop 0
    v_add_f32 v4, 1.0, v4
    v_rcp_f32 v4, v4
    v_add_u32 v5, s29, v1
    v_lshlrev_b32 v5, 2, v5
    v_add_u32 v5, 0x1200000, v5
    v_cmp_gt_u32 vcc, 16, v1
    v_mov_b32 v6, 0x7ffffff0
    s_nop 0
    v_cndmask_b32 v5, v6, v5, vcc
    buffer_store_dword v4, v5, s[20:23], 0 offen
    s_mov_b32 s12, s40
    s_and_b32 s13, s41, 0xffff
    s_mov_b32 s14, 0xc8000
    s_mov_b32 s15, 0x00020000
    s_mov_b32 s16, s42
    s_and_b32 s17, s43, 0xffff
    s_mov_b32 s18, 0xc8000
    s_mov_b32 s19, 0x00020000
    s_mul_i32 s30, s39, 51200
    v_lshlrev_b32 v3, 4, v0
    buffer_load_dwordx4 v[32:35], v3, s[12:15], s30 offen
    buffer_load_dwordx4 v[36:39], v3, s[16:19], s30 offen
    s_add_u32 s30, s30, 8192
    buffer_load_dwordx4 v[40:43], v3, s[12:15], s30 offen
    buffer_load_dwordx4 v[44:47], v3, s[16:19], s30 offen
    s_add_u32 s30, s30, 8192
    buffer_load_dwordx4 v[48:51], v3, s[12:15], s30 offen
    buffer_load_dwordx4 v[52:55], v3, s[16:19], s30 offen
    s_add_u32 s30, s30, 8192
    buffer_load_dwordx4 v[56:59], v3, s[12:15], s30 offen
    buffer_load_dwordx4 v[60:63], v3, s[16:19], s30 offen
    s_add_u32 s30, s30, 8192
    buffer_load_dwordx4 v[64:67], v3, s[12:15], s30 offen
    buffer_load_dwordx4 v[68:71], v3, s[16:19], s30 offen
    s_add_u32 s30, s30, 8192
    buffer_load_dwordx4 v[72:75], v3, s[12:15], s30 offen
    buffer_load_dwordx4 v[76:79], v3, s[16:19], s30 offen
    s_add_u32 s30, s30, 8192
    buffer_load_dwordx4 v[80:83], v3, s[12:15], s30 offen
    buffer_load_dwordx4 v[84:87], v3, s[16:19], s30 offen
    s_waitcnt vmcnt(0)
K1_END:
    s_endpgm
.globl attn_kernel
.p2align 8
.type attn_kernel,@function
attn_kernel:
    s_cmp_ge_u32 s2, 256
    s_cbranch_scc1 K2_END
    s_load_dwordx2 s[26:27], s[0:1], 72
    v_and_b32 v1, 63, v0
    v_lshrrev_b32 v2, 6, v0
    s_nop 0
    v_readfirstlane_b32 s28, v2
    s_and_b32 s29, s2, 31
    s_lshr_b32 s30, s2, 5
    s_waitcnt lgkmcnt(0)
    s_mov_b32 s20, s26
    s_and_b32 s21, s27, 0xffff
    s_mov_b32 s22, 0x1800000
    s_mov_b32 s23, 0x00020000
    v_and_b32 v3, 31, v1
    v_lshrrev_b32 v4, 5, v1
    v_lshlrev_b32 v5, 4, v0
    v_lshlrev_b32 v6, 3, v0
    v_add_u32 v7, 49152, v6
    s_lshl_b32 s31, s29, 6
    s_lshl_b32 s32, s30, 3
    s_add_u32 s32, s32, s28
    v_lshlrev_b32 v8, 4, v1
    v_lshlrev_b32 v9, 3, v3
    v_mov_b32 v10, 0x7ffffff0
    v_cmp_eq_u32 vcc, 0, v4
    s_nop 1
    v_cndmask_b32 v10, v10, v9, vcc
    v_mov_b32 v208, v8
    v_add_u32 v209, 49152, v9
    v_mov_b32 v142, 0
    v_mov_b32 v143, 0
    v_mov_b32 v150, 0
    v_mov_b32 v151, 0
    v_mov_b32 v202, 0xff800000
    v_lshlrev_b32 v11, 2, v4
    v_add_u32 v12, 0, v11
    v_cmp_le_u32 s[64:65], v12, v3
    v_add_u32 v12, 1, v11
    v_cmp_le_u32 s[66:67], v12, v3
    v_add_u32 v12, 2, v11
    v_cmp_le_u32 s[68:69], v12, v3
    v_add_u32 v12, 3, v11
    v_cmp_le_u32 s[70:71], v12, v3
    v_add_u32 v12, 8, v11
    v_cmp_le_u32 s[72:73], v12, v3
    v_add_u32 v12, 9, v11
    v_cmp_le_u32 s[74:75], v12, v3
    v_add_u32 v12, 10, v11
    v_cmp_le_u32 s[76:77], v12, v3
    v_add_u32 v12, 11, v11
    v_cmp_le_u32 s[78:79], v12, v3
    v_add_u32 v12, 16, v11
    v_cmp_le_u32 s[80:81], v12, v3
    v_add_u32 v12, 17, v11
    v_cmp_le_u32 s[82:83], v12, v3
    v_add_u32 v12, 18, v11
    v_cmp_le_u32 s[84:85], v12, v3
    v_add_u32 v12, 19, v11
    v_cmp_le_u32 s[86:87], v12, v3
    v_add_u32 v12, 24, v11
    v_cmp_le_u32 s[88:89], v12, v3
    v_add_u32 v12, 25, v11
    v_cmp_le_u32 s[90:91], v12, v3
    v_add_u32 v12, 26, v11
    v_cmp_le_u32 s[92:93], v12, v3
    v_add_u32 v12, 27, v11
    v_cmp_le_u32 s[94:95], v12, v3
    s_lshl_b32 s33, s32, 5
    v_add_u32 v11, s33, v3
    v_mul_u32_u24 v11, 2560, v11
    s_mul_i32 s33, s29, 40
    s_add_u32 s33, s33, 0x1300000
    v_add_u32 v11, s33, v11
    v_lshl_add_u32 v213, v4, 3, v11
    v_mov_b32 v12, 0x7fffeff0
    v_cmp_eq_u32 vcc, 0, v4
    s_nop 1
    v_cndmask_b32 v214, v12, v213, vcc
    s_add_u32 s33, s31, s32
    s_lshl_b32 s34, s33, 10
    s_add_u32 s34, s34, 0xd00000
    s_lshl_b32 s35, s33, 8
    s_add_u32 s35, s35, 0x1100000
    buffer_load_dwordx4 v[128:131], v8, s[20:23], s34 offen
    buffer_load_dwordx2 v[132:133], v10, s[20:23], s35 offen
    v_mov_b32 v134, 0
    v_mov_b32 v135, 0
    s_add_u32 s33, s31, s32
    s_add_u32 s33, s33, 2048
    s_lshl_b32 s34, s33, 10
    s_add_u32 s34, s34, 0xd00000
    s_lshl_b32 s35, s33, 8
    s_add_u32 s35, s35, 0x1100000
    buffer_load_dwordx4 v[236:239], v8, s[20:23], s34 offen
    buffer_load_dwordx2 v[240:241], v10, s[20:23], s35 offen
    s_mov_b32 s36, s31
    s_mul_i32 s37, s36, 3072
    buffer_load_dwordx4 v[176:179], v5, s[20:23], s37 offen
    s_add_u32 s37, s37, 8192
    buffer_load_dwordx4 v[180:183], v5, s[20:23], s37 offen
    s_add_u32 s37, s37, 8192
    buffer_load_dwordx4 v[184:187], v5, s[20:23], s37 offen
    s_add_u32 s37, s37, 8192
    buffer_load_dwordx4 v[188:191], v5, s[20:23], s37 offen
    s_add_u32 s37, s37, 8192
    buffer_load_dwordx4 v[192:195], v5, s[20:23], s37 offen
    s_add_u32 s37, s37, 8192
    buffer_load_dwordx4 v[196:199], v5, s[20:23], s37 offen
    s_lshl_b32 s37, s36, 8
    s_add_u32 s37, s37, 0xc00000
    buffer_load_dwordx2 v[200:201], v6, s[20:23], s37 offen
    s_waitcnt vmcnt(0)
    s_mov_b32 s38, 0
    v_add_u32 v11, s38, v5
    v_add_u32 v12, s38, v7
    ds_write_b128 v11, v[176:179] offset:0
    ds_write_b128 v11, v[180:183] offset:8192
    ds_write_b128 v11, v[184:187] offset:16384
    ds_write_b128 v11, v[188:191] offset:24576
    ds_write_b128 v11, v[192:195] offset:32768
    ds_write_b128 v11, v[196:199] offset:40960
    ds_write_b64 v12, v[200:201]
    s_waitcnt lgkmcnt(0)
    s_barrier
    v_mov_b32 v96, 0
    v_mov_b32 v112, 0
    v_mov_b32 v97, 0
    v_mov_b32 v113, 0
    v_mov_b32 v98, 0
    v_mov_b32 v114, 0
    v_mov_b32 v99, 0
    v_mov_b32 v115, 0
    v_mov_b32 v100, 0
    v_mov_b32 v116, 0
    v_mov_b32 v101, 0
    v_mov_b32 v117, 0
    v_mov_b32 v102, 0
    v_mov_b32 v118, 0
    v_mov_b32 v103, 0
    v_mov_b32 v119, 0
    v_mov_b32 v104, 0
    v_mov_b32 v120, 0
    v_mov_b32 v105, 0
    v_mov_b32 v121, 0
    v_mov_b32 v106, 0
    v_mov_b32 v122, 0
    v_mov_b32 v107, 0
    v_mov_b32 v123, 0
    v_mov_b32 v108, 0
    v_mov_b32 v124, 0
    v_mov_b32 v109, 0
    v_mov_b32 v125, 0
    v_mov_b32 v110, 0
    v_mov_b32 v126, 0
    v_mov_b32 v111, 0
    v_mov_b32 v127, 0
    v_mov_b32 v203, 0
    s_mov_b32 s39, 0
K2_TILE:
    s_add_u32 s36, s36, 16
    s_cmp_lt_u32 s39, 3
    s_cbranch_scc1 K2_PF
    s_lshl_b32 s40, s30, 3
    s_max_u32 s40, s40, 8
    s_sub_u32 s40, s40, 8
    s_add_u32 s36, s31, s40
    s_add_u32 s36, s36, 2048
K2_PF:
    s_mul_i32 s37, s36, 3072
    buffer_load_dwordx4 v[176:179], v5, s[20:23], s37 offen
    s_add_u32 s37, s37, 8192
    buffer_load_dwordx4 v[180:183], v5, s[20:23], s37 offen
    s_add_u32 s37, s37, 8192
    buffer_load_dwordx4 v[184:187], v5, s[20:23], s37 offen
    s_add_u32 s37, s37, 8192
    buffer_load_dwordx4 v[188:191], v5, s[20:23], s37 offen
    s_add_u32 s37, s37, 8192
    buffer_load_dwordx4 v[192:195], v5, s[20:23], s37 offen
    s_add_u32 s37, s37, 8192
    buffer_load_dwordx4 v[196:199], v5, s[20:23], s37 offen
    s_lshl_b32 s37, s36, 8
    s_add_u32 s37, s37, 0xc00000
    buffer_load_dwordx2 v[200:201], v6, s[20:23], s37 offen
    s_cmp_lg_u32 s39, 0
    s_cbranch_scc1 K2_NOINIT
    ds_read_b128 v[136:139], v208 offset:0
    ds_read_b64 v[140:141], v209 offset:0
    s_waitcnt lgkmcnt(0)
    v_mfma_f32_32x32x16_bf16 v[32:47], v[136:139], v[128:131], v[96:111]
    v_mfma_f32_32x32x16_bf16 v[32:47], v[140:143], v[132:135], v[32:47]
    s_nop 15
RARE_INIT:
    v_max3_f32 v204, v32, v33, v34
    v_max3_f32 v205, v35, v36, v37
    v_max3_f32 v204, v204, v38, v39
    v_max3_f32 v205, v205, v40, v41
    v_max3_f32 v204, v204, v42, v43
    v_max3_f32 v205, v205, v44, v45
    v_max3_f32 v204, v204, v46, v47
    v_max_f32 v204, v204, v205
    v_mov_b32 v205, v204
    s_nop 1
    v_permlane32_swap_b32 v204, v205
    v_max_f32 v204, v204, v205
    v_add_f32 v204, 0x42a00000, v204
    v_max_f32 v205, 0, v204
    v_sub_f32 v205, 0, v205
    v_exp_f32 v205, v205
    v_sub_f32 v203, v203, v204
    v_mov_b32 v96, v203
    v_mov_b32 v97, v203
    v_mov_b32 v98, v203
    v_mov_b32 v99, v203
    v_mov_b32 v100, v203
    v_mov_b32 v101, v203
    v_mov_b32 v102, v203
    v_mov_b32 v103, v203
    v_mov_b32 v104, v203
    v_mov_b32 v105, v203
    v_mov_b32 v106, v203
    v_mov_b32 v107, v203
    v_mov_b32 v108, v203
    v_mov_b32 v109, v203
    v_mov_b32 v110, v203
    v_mov_b32 v111, v203
    v_mul_f32 v112, v112, v205
    v_mul_f32 v113, v113, v205
    v_mul_f32 v114, v114, v205
    v_mul_f32 v115, v115, v205
    v_mul_f32 v116, v116, v205
    v_mul_f32 v117, v117, v205
    v_mul_f32 v118, v118, v205
    v_mul_f32 v119, v119, v205
    v_mul_f32 v120, v120, v205
    v_mul_f32 v121, v121, v205
    v_mul_f32 v122, v122, v205
    v_mul_f32 v123, v123, v205
    v_mul_f32 v124, v124, v205
    v_mul_f32 v125, v125, v205
    v_mul_f32 v126, v126, v205
    v_mul_f32 v127, v127, v205
    v_sub_f32 v32, v32, v204
    v_sub_f32 v33, v33, v204
    v_sub_f32 v34, v34, v204
    v_sub_f32 v35, v35, v204
    v_sub_f32 v36, v36, v204
    v_sub_f32 v37, v37, v204
    v_sub_f32 v38, v38, v204
    v_sub_f32 v39, v39, v204
    v_sub_f32 v40, v40, v204
    v_sub_f32 v41, v41, v204
    v_sub_f32 v42, v42, v204
    v_sub_f32 v43, v43, v204
    v_sub_f32 v44, v44, v204
    v_sub_f32 v45, v45, v204
    v_sub_f32 v46, v46, v204
    v_sub_f32 v47, v47, v204
    v_exp_f32 v64, v32
    v_exp_f32 v65, v33
    v_exp_f32 v66, v34
    v_exp_f32 v67, v35
    v_exp_f32 v68, v36
    v_exp_f32 v69, v37
    v_exp_f32 v70, v38
    v_exp_f32 v71, v39
    v_exp_f32 v72, v40
    v_exp_f32 v73, v41
    v_exp_f32 v74, v42
    v_exp_f32 v75, v43
    v_exp_f32 v76, v44
    v_exp_f32 v77, v45
    v_exp_f32 v78, v46
    v_exp_f32 v79, v47
    v_cvt_pk_bf16_f32 v80, v64, v65
    v_cvt_pk_bf16_f32 v81, v66, v67
    v_cvt_pk_bf16_f32 v82, v68, v69
    v_cvt_pk_bf16_f32 v83, v70, v71
    v_cvt_pk_bf16_f32 v84, v72, v73
    v_cvt_pk_bf16_f32 v85, v74, v75
    v_cvt_pk_bf16_f32 v86, v76, v77
    v_cvt_pk_bf16_f32 v87, v78, v79
    s_nop 1
K2_NOINIT:
    v_mov_b32 v216, v112
    v_mov_b32 v217, v113
    v_mov_b32 v218, v114
    v_mov_b32 v219, v115
    v_mov_b32 v220, v116
    v_mov_b32 v221, v117
    v_mov_b32 v222, v118
    v_mov_b32 v223, v119
    v_mov_b32 v224, v120
    v_mov_b32 v225, v121
    v_mov_b32 v226, v122
    v_mov_b32 v227, v123
    v_mov_b32 v228, v124
    v_mov_b32 v229, v125
    v_mov_b32 v230, v126
    v_mov_b32 v231, v127
    v_mov_b32 v232, v203
    ds_read_b128 v[136:139], v208 offset:0
    ds_read_b64 v[140:141], v209 offset:0
    v_mov_b32 v80, 0
    v_mov_b32 v81, 0
    v_mov_b32 v82, 0
    v_mov_b32 v83, 0
    v_mov_b32 v84, 0
    v_mov_b32 v85, 0
    v_mov_b32 v86, 0
    v_mov_b32 v87, 0
    s_waitcnt lgkmcnt(0)
    v_mfma_f32_32x32x16_bf16 v[32:47], v[136:139], v[128:131], v[96:111]
    v_mfma_f32_32x32x16_bf16 v[32:47], v[140:143], v[132:135], v[32:47]
    ds_read_b128 v[136:139], v208 offset:3072
    ds_read_b64 v[140:141], v209 offset:256
    ds_read_b128 v[152:155], v208 offset:1024
    ds_read_b128 v[156:159], v208 offset:2048
    s_nop 9
    s_xor_b32 s33, s38, 53248
    v_add_u32 v11, s33, v5
    v_add_u32 v12, s33, v7
    s_waitcnt lgkmcnt(2)
    v_mfma_f32_32x32x16_bf16 v[48:63], v[136:139], v[128:131], v[96:111]
    v_exp_f32 v64, v32
    v_exp_f32 v65, v33
    v_exp_f32 v66, v34
    v_exp_f32 v67, v35
    v_mfma_f32_32x32x16_bf16 v[48:63], v[140:143], v[132:135], v[48:63]
    ds_read_b128 v[136:139], v208 offset:6144
    ds_read_b64 v[140:141], v209 offset:512
    v_exp_f32 v68, v36
    v_exp_f32 v69, v37
    v_exp_f32 v70, v38
    v_exp_f32 v71, v39
    s_waitcnt lgkmcnt(2)
    v_mfma_f32_32x32x16_bf16 v[112:127], v[152:155], v[80:83], v[112:127]
    v_exp_f32 v72, v40
    v_exp_f32 v73, v41
    v_exp_f32 v74, v42
    v_exp_f32 v75, v43
    v_mfma_f32_32x32x16_bf16 v[112:127], v[156:159], v[84:87], v[112:127]
    ds_read_b128 v[152:155], v208 offset:1024
    ds_read_b128 v[156:159], v208 offset:2048
    v_exp_f32 v76, v44
    v_exp_f32 v77, v45
    v_exp_f32 v78, v46
    v_exp_f32 v79, v47
    v_cvt_pk_bf16_f32 v80, v64, v65
    v_cvt_pk_bf16_f32 v81, v66, v67
    v_cvt_pk_bf16_f32 v82, v68, v69
    v_cvt_pk_bf16_f32 v83, v70, v71
    v_cvt_pk_bf16_f32 v84, v72, v73
    v_cvt_pk_bf16_f32 v85, v74, v75
    v_cvt_pk_bf16_f32 v86, v76, v77
    v_cvt_pk_bf16_f32 v87, v78, v79
    s_waitcnt lgkmcnt(2)
    v_mfma_f32_32x32x16_bf16 v[32:47], v[136:139], v[128:131], v[96:111]
    v_exp_f32 v64, v48
    v_exp_f32 v65, v49
    v_exp_f32 v66, v50
    v_exp_f32 v67, v51
    v_mfma_f32_32x32x16_bf16 v[32:47], v[140:143], v[132:135], v[32:47]
    ds_read_b128 v[136:139], v208 offset:9216
    ds_read_b64 v[140:141], v209 offset:768
    v_exp_f32 v68, v52
    v_exp_f32 v69, v53
    v_exp_f32 v70, v54
    v_exp_f32 v71, v55
    s_waitcnt lgkmcnt(2)
    v_mfma_f32_32x32x16_bf16 v[112:127], v[152:155], v[80:83], v[112:127]
    v_exp_f32 v72, v56
    v_exp_f32 v73, v57
    v_exp_f32 v74, v58
    v_exp_f32 v75, v59
    v_mfma_f32_32x32x16_bf16 v[112:127], v[156:159], v[84:87], v[112:127]
    ds_read_b128 v[152:155], v208 offset:4096
    ds_read_b128 v[156:159], v208 offset:5120
    v_exp_f32 v76, v60
    v_exp_f32 v77, v61
    v_exp_f32 v78, v62
    v_exp_f32 v79, v63
    v_cvt_pk_bf16_f32 v80, v64, v65
    v_cvt_pk_bf16_f32 v81, v66, v67
    v_cvt_pk_bf16_f32 v82, v68, v69
    v_cvt_pk_bf16_f32 v83, v70, v71
    v_cvt_pk_bf16_f32 v84, v72, v73
    v_cvt_pk_bf16_f32 v85, v74, v75
    v_cvt_pk_bf16_f32 v86, v76, v77
    v_cvt_pk_bf16_f32 v87, v78, v79
    s_waitcnt lgkmcnt(2)
    v_mfma_f32_32x32x16_bf16 v[48:63], v[136:139], v[128:131], v[96:111]
    v_exp_f32 v64, v32
    v_exp_f32 v65, v33
    v_exp_f32 v66, v34
    v_exp_f32 v67, v35
    v_mfma_f32_32x32x16_bf16 v[48:63], v[140:143], v[132:135], v[48:63]
    ds_read_b128 v[136:139], v208 offset:12288
    ds_read_b64 v[140:141], v209 offset:1024
    v_exp_f32 v68, v36
    v_exp_f32 v69, v37
    v_exp_f32 v70, v38
    v_exp_f32 v71, v39
    s_waitcnt lgkmcnt(2)
    v_mfma_f32_32x32x16_bf16 v[112:127], v[152:155], v[80:83], v[112:127]
    v_exp_f32 v72, v40
    v_exp_f32 v73, v41
    v_exp_f32 v74, v42
    v_exp_f32 v75, v43
    v_mfma_f32_32x32x16_bf16 v[112:127], v[156:159], v[84:87], v[112:127]
    ds_read_b128 v[152:155], v208 offset:7168
    ds_read_b128 v[156:159], v208 offset:8192
    v_exp_f32 v76, v44
    v_exp_f32 v77, v45
    v_exp_f32 v78, v46
    v_exp_f32 v79, v47
    v_cvt_pk_bf16_f32 v80, v64, v65
    v_cvt_pk_bf16_f32 v81, v66, v67
    v_cvt_pk_bf16_f32 v82, v68, v69
    v_cvt_pk_bf16_f32 v83, v70, v71
    v_cvt_pk_bf16_f32 v84, v72, v73
    v_cvt_pk_bf16_f32 v85, v74, v75
    v_cvt_pk_bf16_f32 v86, v76, v77
    v_cvt_pk_bf16_f32 v87, v78, v79
    s_waitcnt lgkmcnt(2)
    v_mfma_f32_32x32x16_bf16 v[32:47], v[136:139], v[128:131], v[96:111]
    v_exp_f32 v64, v48
    v_exp_f32 v65, v49
    v_exp_f32 v66, v50
    v_exp_f32 v67, v51
    v_mfma_f32_32x32x16_bf16 v[32:47], v[140:143], v[132:135], v[32:47]
    ds_read_b128 v[136:139], v208 offset:15360
    ds_read_b64 v[140:141], v209 offset:1280
    v_exp_f32 v68, v52
    v_exp_f32 v69, v53
    v_exp_f32 v70, v54
    v_exp_f32 v71, v55
    s_waitcnt lgkmcnt(2)
    v_mfma_f32_32x32x16_bf16 v[112:127], v[152:155], v[80:83], v[112:127]
    v_exp_f32 v72, v56
    v_exp_f32 v73, v57
    v_exp_f32 v74, v58
    v_exp_f32 v75, v59
    v_mfma_f32_32x32x16_bf16 v[112:127], v[156:159], v[84:87], v[112:127]
    ds_read_b128 v[152:155], v208 offset:10240
    ds_read_b128 v[156:159], v208 offset:11264
    v_exp_f32 v76, v60
    v_exp_f32 v77, v61
    v_exp_f32 v78, v62
    v_exp_f32 v79, v63
    v_cvt_pk_bf16_f32 v80, v64, v65
    v_cvt_pk_bf16_f32 v81, v66, v67
    v_cvt_pk_bf16_f32 v82, v68, v69
    v_cvt_pk_bf16_f32 v83, v70, v71
    v_cvt_pk_bf16_f32 v84, v72, v73
    v_cvt_pk_bf16_f32 v85, v74, v75
    v_cvt_pk_bf16_f32 v86, v76, v77
    v_cvt_pk_bf16_f32 v87, v78, v79
    s_waitcnt lgkmcnt(2)
    v_mfma_f32_32x32x16_bf16 v[48:63], v[136:139], v[128:131], v[96:111]
    v_exp_f32 v64, v32
    v_exp_f32 v65, v33
    v_exp_f32 v66, v34
    v_exp_f32 v67, v35
    v_mfma_f32_32x32x16_bf16 v[48:63], v[140:143], v[132:135], v[48:63]
    ds_read_b128 v[136:139], v208 offset:18432
    ds_read_b64 v[140:141], v209 offset:1536
    v_exp_f32 v68, v36
    v_exp_f32 v69, v37
    v_exp_f32 v70, v38
    v_exp_f32 v71, v39
    s_waitcnt lgkmcnt(2)
    v_mfma_f32_32x32x16_bf16 v[112:127], v[152:155], v[80:83], v[112:127]
    v_exp_f32 v72, v40
    v_exp_f32 v73, v41
    v_exp_f32 v74, v42
    v_exp_f32 v75, v43
    v_mfma_f32_32x32x16_bf16 v[112:127], v[156:159], v[84:87], v[112:127]
    ds_read_b128 v[152:155], v208 offset:13312
    ds_read_b128 v[156:159], v208 offset:14336
    v_exp_f32 v76, v44
    v_exp_f32 v77, v45
    v_exp_f32 v78, v46
    v_exp_f32 v79, v47
    v_cvt_pk_bf16_f32 v80, v64, v65
    v_cvt_pk_bf16_f32 v81, v66, v67
    v_cvt_pk_bf16_f32 v82, v68, v69
    v_cvt_pk_bf16_f32 v83, v70, v71
    v_cvt_pk_bf16_f32 v84, v72, v73
    v_cvt_pk_bf16_f32 v85, v74, v75
    v_cvt_pk_bf16_f32 v86, v76, v77
    v_cvt_pk_bf16_f32 v87, v78, v79
    s_waitcnt lgkmcnt(2)
    v_mfma_f32_32x32x16_bf16 v[32:47], v[136:139], v[128:131], v[96:111]
    v_exp_f32 v64, v48
    v_exp_f32 v65, v49
    v_exp_f32 v66, v50
    v_exp_f32 v67, v51
    v_mfma_f32_32x32x16_bf16 v[32:47], v[140:143], v[132:135], v[32:47]
    ds_read_b128 v[136:139], v208 offset:21504
    ds_read_b64 v[140:141], v209 offset:1792
    v_exp_f32 v68, v52
    v_exp_f32 v69, v53
    v_exp_f32 v70, v54
    v_exp_f32 v71, v55
    s_waitcnt lgkmcnt(2)
    v_mfma_f32_32x32x16_bf16 v[112:127], v[152:155], v[80:83], v[112:127]
    v_exp_f32 v72, v56
    v_exp_f32 v73, v57
    v_exp_f32 v74, v58
    v_exp_f32 v75, v59
    v_mfma_f32_32x32x16_bf16 v[112:127], v[156:159], v[84:87], v[112:127]
    ds_read_b128 v[152:155], v208 offset:16384
    ds_read_b128 v[156:159], v208 offset:17408
    v_exp_f32 v76, v60
    v_exp_f32 v77, v61
    v_exp_f32 v78, v62
    v_exp_f32 v79, v63
    v_cvt_pk_bf16_f32 v80, v64, v65
    v_cvt_pk_bf16_f32 v81, v66, v67
    v_cvt_pk_bf16_f32 v82, v68, v69
    v_cvt_pk_bf16_f32 v83, v70, v71
    v_cvt_pk_bf16_f32 v84, v72, v73
    v_cvt_pk_bf16_f32 v85, v74, v75
    v_cvt_pk_bf16_f32 v86, v76, v77
    v_cvt_pk_bf16_f32 v87, v78, v79
    s_waitcnt lgkmcnt(2)
    v_mfma_f32_32x32x16_bf16 v[48:63], v[136:139], v[128:131], v[96:111]
    v_exp_f32 v64, v32
    v_exp_f32 v65, v33
    v_exp_f32 v66, v34
    v_exp_f32 v67, v35
    v_mfma_f32_32x32x16_bf16 v[48:63], v[140:143], v[132:135], v[48:63]
    ds_read_b128 v[136:139], v208 offset:24576
    ds_read_b64 v[140:141], v209 offset:2048
    v_exp_f32 v68, v36
    v_exp_f32 v69, v37
    v_exp_f32 v70, v38
    v_exp_f32 v71, v39
    s_waitcnt lgkmcnt(2)
    v_mfma_f32_32x32x16_bf16 v[112:127], v[152:155], v[80:83], v[112:127]
    v_exp_f32 v72, v40
    v_exp_f32 v73, v41
    v_exp_f32 v74, v42
    v_exp_f32 v75, v43
    v_mfma_f32_32x32x16_bf16 v[112:127], v[156:159], v[84:87], v[112:127]
    ds_read_b128 v[152:155], v208 offset:19456
    ds_read_b128 v[156:159], v208 offset:20480
    v_exp_f32 v76, v44
    v_exp_f32 v77, v45
    v_exp_f32 v78, v46
    v_exp_f32 v79, v47
    v_cvt_pk_bf16_f32 v80, v64, v65
    v_cvt_pk_bf16_f32 v81, v66, v67
    v_cvt_pk_bf16_f32 v82, v68, v69
    v_cvt_pk_bf16_f32 v83, v70, v71
    v_cvt_pk_bf16_f32 v84, v72, v73
    v_cvt_pk_bf16_f32 v85, v74, v75
    v_cvt_pk_bf16_f32 v86, v76, v77
    v_cvt_pk_bf16_f32 v87, v78, v79
    s_waitcnt lgkmcnt(2)
    v_mfma_f32_32x32x16_bf16 v[32:47], v[136:139], v[128:131], v[96:111]
    v_exp_f32 v64, v48
    v_exp_f32 v65, v49
    v_exp_f32 v66, v50
    v_exp_f32 v67, v51
    v_mfma_f32_32x32x16_bf16 v[32:47], v[140:143], v[132:135], v[32:47]
    ds_read_b128 v[136:139], v208 offset:27648
    ds_read_b64 v[140:141], v209 offset:2304
    v_exp_f32 v68, v52
    v_exp_f32 v69, v53
    v_exp_f32 v70, v54
    v_exp_f32 v71, v55
    s_waitcnt lgkmcnt(2)
    v_mfma_f32_32x32x16_bf16 v[112:127], v[152:155], v[80:83], v[112:127]
    v_exp_f32 v72, v56
    v_exp_f32 v73, v57
    v_exp_f32 v74, v58
    v_exp_f32 v75, v59
    v_mfma_f32_32x32x16_bf16 v[112:127], v[156:159], v[84:87], v[112:127]
    ds_read_b128 v[152:155], v208 offset:22528
    ds_read_b128 v[156:159], v208 offset:23552
    v_exp_f32 v76, v60
    v_exp_f32 v77, v61
    v_exp_f32 v78, v62
    v_exp_f32 v79, v63
    v_cvt_pk_bf16_f32 v80, v64, v65
    v_cvt_pk_bf16_f32 v81, v66, v67
    v_cvt_pk_bf16_f32 v82, v68, v69
    v_cvt_pk_bf16_f32 v83, v70, v71
    v_cvt_pk_bf16_f32 v84, v72, v73
    v_cvt_pk_bf16_f32 v85, v74, v75
    v_cvt_pk_bf16_f32 v86, v76, v77
    v_cvt_pk_bf16_f32 v87, v78, v79
    s_waitcnt lgkmcnt(2)
    v_mfma_f32_32x32x16_bf16 v[48:63], v[136:139], v[128:131], v[96:111]
    v_exp_f32 v64, v32
    v_exp_f32 v65, v33
    v_exp_f32 v66, v34
    v_exp_f32 v67, v35
    v_mfma_f32_32x32x16_bf16 v[48:63], v[140:143], v[132:135], v[48:63]
    ds_read_b128 v[136:139], v208 offset:30720
    ds_read_b64 v[140:141], v209 offset:2560
    v_exp_f32 v68, v36
    v_exp_f32 v69, v37
    v_exp_f32 v70, v38
    v_exp_f32 v71, v39
    s_waitcnt lgkmcnt(2)
    v_mfma_f32_32x32x16_bf16 v[112:127], v[152:155], v[80:83], v[112:127]
    v_exp_f32 v72, v40
    v_exp_f32 v73, v41
    v_exp_f32 v74, v42
    v_exp_f32 v75, v43
    v_mfma_f32_32x32x16_bf16 v[112:127], v[156:159], v[84:87], v[112:127]
    ds_read_b128 v[152:155], v208 offset:25600
    ds_read_b128 v[156:159], v208 offset:26624
    v_exp_f32 v76, v44
    v_exp_f32 v77, v45
    v_exp_f32 v78, v46
    v_exp_f32 v79, v47
    v_cvt_pk_bf16_f32 v80, v64, v65
    v_cvt_pk_bf16_f32 v81, v66, v67
    v_cvt_pk_bf16_f32 v82, v68, v69
    v_cvt_pk_bf16_f32 v83, v70, v71
    v_cvt_pk_bf16_f32 v84, v72, v73
    v_cvt_pk_bf16_f32 v85, v74, v75
    v_cvt_pk_bf16_f32 v86, v76, v77
    v_cvt_pk_bf16_f32 v87, v78, v79
    s_waitcnt lgkmcnt(2)
    s_waitcnt vmcnt(0)
    ds_write_b128 v11, v[176:179] offset:0
    v_mfma_f32_32x32x16_bf16 v[32:47], v[136:139], v[128:131], v[96:111]
    v_exp_f32 v64, v48
    v_exp_f32 v65, v49
    v_exp_f32 v66, v50
    v_exp_f32 v67, v51
    v_mfma_f32_32x32x16_bf16 v[32:47], v[140:143], v[132:135], v[32:47]
    ds_read_b128 v[136:139], v208 offset:33792
    ds_read_b64 v[140:141], v209 offset:2816
    v_exp_f32 v68, v52
    v_exp_f32 v69, v53
    v_exp_f32 v70, v54
    v_exp_f32 v71, v55
    s_waitcnt lgkmcnt(3)
    v_mfma_f32_32x32x16_bf16 v[112:127], v[152:155], v[80:83], v[112:127]
    v_exp_f32 v72, v56
    v_exp_f32 v73, v57
    v_exp_f32 v74, v58
    v_exp_f32 v75, v59
    v_mfma_f32_32x32x16_bf16 v[112:127], v[156:159], v[84:87], v[112:127]
    ds_read_b128 v[152:155], v208 offset:28672
    ds_read_b128 v[156:159], v208 offset:29696
    v_exp_f32 v76, v60
    v_exp_f32 v77, v61
    v_exp_f32 v78, v62
    v_exp_f32 v79, v63
    v_cvt_pk_bf16_f32 v80, v64, v65
    v_cvt_pk_bf16_f32 v81, v66, v67
    v_cvt_pk_bf16_f32 v82, v68, v69
    v_cvt_pk_bf16_f32 v83, v70, v71
    v_cvt_pk_bf16_f32 v84, v72, v73
    v_cvt_pk_bf16_f32 v85, v74, v75
    v_cvt_pk_bf16_f32 v86, v76, v77
    v_cvt_pk_bf16_f32 v87, v78, v79
    s_waitcnt lgkmcnt(2)
    ds_write_b128 v11, v[180:183] offset:8192
    v_mfma_f32_32x32x16_bf16 v[48:63], v[136:139], v[128:131], v[96:111]
    v_exp_f32 v64, v32
    v_exp_f32 v65, v33
    v_exp_f32 v66, v34
    v_exp_f32 v67, v35
    v_mfma_f32_32x32x16_bf16 v[48:63], v[140:143], v[132:135], v[48:63]
    ds_read_b128 v[136:139], v208 offset:36864
    ds_read_b64 v[140:141], v209 offset:3072
    v_exp_f32 v68, v36
    v_exp_f32 v69, v37
    v_exp_f32 v70, v38
    v_exp_f32 v71, v39
    s_waitcnt lgkmcnt(3)
    v_mfma_f32_32x32x16_bf16 v[112:127], v[152:155], v[80:83], v[112:127]
    v_exp_f32 v72, v40
    v_exp_f32 v73, v41
    v_exp_f32 v74, v42
    v_exp_f32 v75, v43
    v_mfma_f32_32x32x16_bf16 v[112:127], v[156:159], v[84:87], v[112:127]
    ds_read_b128 v[152:155], v208 offset:31744
    ds_read_b128 v[156:159], v208 offset:32768
    v_exp_f32 v76, v44
    v_exp_f32 v77, v45
    v_exp_f32 v78, v46
    v_exp_f32 v79, v47
    v_cvt_pk_bf16_f32 v80, v64, v65
    v_cvt_pk_bf16_f32 v81, v66, v67
    v_cvt_pk_bf16_f32 v82, v68, v69
    v_cvt_pk_bf16_f32 v83, v70, v71
    v_cvt_pk_bf16_f32 v84, v72, v73
    v_cvt_pk_bf16_f32 v85, v74, v75
    v_cvt_pk_bf16_f32 v86, v76, v77
    v_cvt_pk_bf16_f32 v87, v78, v79
    s_waitcnt lgkmcnt(2)
    ds_write_b128 v11, v[184:187] offset:16384
    v_mfma_f32_32x32x16_bf16 v[32:47], v[136:139], v[128:131], v[96:111]
    v_exp_f32 v64, v48
    v_exp_f32 v65, v49
    v_exp_f32 v66, v50
    v_exp_f32 v67, v51
    v_mfma_f32_32x32x16_bf16 v[32:47], v[140:143], v[132:135], v[32:47]
    ds_read_b128 v[136:139], v208 offset:39936
    ds_read_b64 v[140:141], v209 offset:3328
    v_exp_f32 v68, v52
    v_exp_f32 v69, v53
    v_exp_f32 v70, v54
    v_exp_f32 v71, v55
    s_waitcnt lgkmcnt(3)
    v_mfma_f32_32x32x16_bf16 v[112:127], v[152:155], v[80:83], v[112:127]
    v_exp_f32 v72, v56
    v_exp_f32 v73, v57
    v_exp_f32 v74, v58
    v_exp_f32 v75, v59
    v_mfma_f32_32x32x16_bf16 v[112:127], v[156:159], v[84:87], v[112:127]
    ds_read_b128 v[152:155], v208 offset:34816
    ds_read_b128 v[156:159], v208 offset:35840
    v_exp_f32 v76, v60
    v_exp_f32 v77, v61
    v_exp_f32 v78, v62
    v_exp_f32 v79, v63
    v_cvt_pk_bf16_f32 v80, v64, v65
    v_cvt_pk_bf16_f32 v81, v66, v67
    v_cvt_pk_bf16_f32 v82, v68, v69
    v_cvt_pk_bf16_f32 v83, v70, v71
    v_cvt_pk_bf16_f32 v84, v72, v73
    v_cvt_pk_bf16_f32 v85, v74, v75
    v_cvt_pk_bf16_f32 v86, v76, v77
    v_cvt_pk_bf16_f32 v87, v78, v79
    s_waitcnt lgkmcnt(2)
    ds_write_b128 v11, v[188:191] offset:24576
    v_mfma_f32_32x32x16_bf16 v[48:63], v[136:139], v[128:131], v[96:111]
    v_exp_f32 v64, v32
    v_exp_f32 v65, v33
    v_exp_f32 v66, v34
    v_exp_f32 v67, v35
    v_mfma_f32_32x32x16_bf16 v[48:63], v[140:143], v[132:135], v[48:63]
    ds_read_b128 v[136:139], v208 offset:43008
    ds_read_b64 v[140:141], v209 offset:3584
    v_exp_f32 v68, v36
    v_exp_f32 v69, v37
    v_exp_f32 v70, v38
    v_exp_f32 v71, v39
    s_waitcnt lgkmcnt(3)
    v_mfma_f32_32x32x16_bf16 v[112:127], v[152:155], v[80:83], v[112:127]
    v_exp_f32 v72, v40
    v_exp_f32 v73, v41
    v_exp_f32 v74, v42
    v_exp_f32 v75, v43
    v_mfma_f32_32x32x16_bf16 v[112:127], v[156:159], v[84:87], v[112:127]
    ds_read_b128 v[152:155], v208 offset:37888
    ds_read_b128 v[156:159], v208 offset:38912
    v_exp_f32 v76, v44
    v_exp_f32 v77, v45
    v_exp_f32 v78, v46
    v_exp_f32 v79, v47
    v_cvt_pk_bf16_f32 v80, v64, v65
    v_cvt_pk_bf16_f32 v81, v66, v67
    v_cvt_pk_bf16_f32 v82, v68, v69
    v_cvt_pk_bf16_f32 v83, v70, v71
    v_cvt_pk_bf16_f32 v84, v72, v73
    v_cvt_pk_bf16_f32 v85, v74, v75
    v_cvt_pk_bf16_f32 v86, v76, v77
    v_cvt_pk_bf16_f32 v87, v78, v79
    s_waitcnt lgkmcnt(2)
    ds_write_b128 v11, v[192:195] offset:32768
    v_mfma_f32_32x32x16_bf16 v[32:47], v[136:139], v[128:131], v[96:111]
    v_exp_f32 v64, v48
    v_exp_f32 v65, v49
    v_exp_f32 v66, v50
    v_exp_f32 v67, v51
    v_mfma_f32_32x32x16_bf16 v[32:47], v[140:143], v[132:135], v[32:47]
    ds_read_b128 v[136:139], v208 offset:46080
    ds_read_b64 v[140:141], v209 offset:3840
    v_exp_f32 v68, v52
    v_exp_f32 v69, v53
    v_exp_f32 v70, v54
    v_exp_f32 v71, v55
    s_waitcnt lgkmcnt(3)
    v_mfma_f32_32x32x16_bf16 v[112:127], v[152:155], v[80:83], v[112:127]
    v_exp_f32 v72, v56
    v_exp_f32 v73, v57
    v_exp_f32 v74, v58
    v_exp_f32 v75, v59
    v_mfma_f32_32x32x16_bf16 v[112:127], v[156:159], v[84:87], v[112:127]
    ds_read_b128 v[152:155], v208 offset:40960
    ds_read_b128 v[156:159], v208 offset:41984
    v_exp_f32 v76, v60
    v_exp_f32 v77, v61
    v_exp_f32 v78, v62
    v_exp_f32 v79, v63
    v_cvt_pk_bf16_f32 v80, v64, v65
    v_cvt_pk_bf16_f32 v81, v66, v67
    v_cvt_pk_bf16_f32 v82, v68, v69
    v_cvt_pk_bf16_f32 v83, v70, v71
    v_cvt_pk_bf16_f32 v84, v72, v73
    v_cvt_pk_bf16_f32 v85, v74, v75
    v_cvt_pk_bf16_f32 v86, v76, v77
    v_cvt_pk_bf16_f32 v87, v78, v79
    s_waitcnt lgkmcnt(2)
    ds_write_b128 v11, v[196:199] offset:40960
    v_mfma_f32_32x32x16_bf16 v[48:63], v[136:139], v[128:131], v[96:111]
    v_exp_f32 v64, v32
    v_exp_f32 v65, v33
    v_exp_f32 v66, v34
    v_exp_f32 v67, v35
    v_mfma_f32_32x32x16_bf16 v[48:63], v[140:143], v[132:135], v[48:63]
    ds_read_b128 v[136:139], v208 offset:49152
    ds_read_b64 v[140:141], v209 offset:4096
    v_exp_f32 v68, v36
    v_exp_f32 v69, v37
    v_exp_f32 v70, v38
    v_exp_f32 v71, v39
    s_waitcnt lgkmcnt(3)
    v_mfma_f32_32x32x16_bf16 v[112:127], v[152:155], v[80:83], v[112:127]
    v_exp_f32 v72, v40
    v_exp_f32 v73, v41
    v_exp_f32 v74, v42
    v_exp_f32 v75, v43
    v_mfma_f32_32x32x16_bf16 v[112:127], v[156:159], v[84:87], v[112:127]
    ds_read_b128 v[152:155], v208 offset:44032
    ds_read_b128 v[156:159], v208 offset:45056
    v_exp_f32 v76, v44
    v_exp_f32 v77, v45
    v_exp_f32 v78, v46
    v_exp_f32 v79, v47
    v_cvt_pk_bf16_f32 v80, v64, v65
    v_cvt_pk_bf16_f32 v81, v66, v67
    v_cvt_pk_bf16_f32 v82, v68, v69
    v_cvt_pk_bf16_f32 v83, v70, v71
    v_cvt_pk_bf16_f32 v84, v72, v73
    v_cvt_pk_bf16_f32 v85, v74, v75
    v_cvt_pk_bf16_f32 v86, v76, v77
    v_cvt_pk_bf16_f32 v87, v78, v79
    s_waitcnt lgkmcnt(2)
    ds_write_b64 v12, v[200:201]
    v_exp_f32 v64, v48
    v_exp_f32 v65, v49
    v_exp_f32 v66, v50
    v_exp_f32 v67, v51
    v_exp_f32 v68, v52
    v_exp_f32 v69, v53
    v_exp_f32 v70, v54
    v_exp_f32 v71, v55
    s_waitcnt lgkmcnt(1)
    v_mfma_f32_32x32x16_bf16 v[112:127], v[152:155], v[80:83], v[112:127]
    v_exp_f32 v72, v56
    v_exp_f32 v73, v57
    v_exp_f32 v74, v58
    v_exp_f32 v75, v59
    v_mfma_f32_32x32x16_bf16 v[112:127], v[156:159], v[84:87], v[112:127]
    ds_read_b128 v[152:155], v208 offset:47104
    ds_read_b128 v[156:159], v208 offset:48128
    v_exp_f32 v76, v60
    v_exp_f32 v77, v61
    v_exp_f32 v78, v62
    v_exp_f32 v79, v63
    v_cvt_pk_bf16_f32 v80, v64, v65
    v_cvt_pk_bf16_f32 v81, v66, v67
    v_cvt_pk_bf16_f32 v82, v68, v69
    v_cvt_pk_bf16_f32 v83, v70, v71
    v_cvt_pk_bf16_f32 v84, v72, v73
    v_cvt_pk_bf16_f32 v85, v74, v75
    v_cvt_pk_bf16_f32 v86, v76, v77
    v_cvt_pk_bf16_f32 v87, v78, v79
    s_waitcnt lgkmcnt(0)
    v_mfma_f32_32x32x16_bf16 v[112:127], v[152:155], v[80:83], v[112:127]
    v_mfma_f32_32x32x16_bf16 v[112:127], v[156:159], v[84:87], v[112:127]
    s_nop 15
    v_cmp_ngt_f32 vcc, 0x53800000, v120
    s_cbranch_vccnz K2_SLOW
K2_TILE_DONE:
    s_waitcnt vmcnt(0) lgkmcnt(0)
    s_xor_b32 s38, s38, 53248
    v_lshlrev_b32 v208, 4, v1
    v_add_u32 v208, s38, v208
    v_lshlrev_b32 v209, 3, v3
    v_add_u32 v209, s38, v209
    v_add_u32 v209, 49152, v209
    s_waitcnt lgkmcnt(0)
    s_barrier
    s_add_u32 s39, s39, 1
    s_cmp_lt_u32 s39, 4
    s_cbranch_scc1 K2_TILE
    s_nop 15
    v_mov_b32 v204, v120
    v_mov_b32 v205, v120
    s_nop 1
    v_permlane32_swap_b32 v204, v205
    v_rcp_f32 v205, v205
    s_nop 0
    v_mul_f32 v112, v112, v205
    v_mul_f32 v113, v113, v205
    v_mul_f32 v114, v114, v205
    v_mul_f32 v115, v115, v205
    v_mul_f32 v116, v116, v205
    v_mul_f32 v117, v117, v205
    v_mul_f32 v118, v118, v205
    v_mul_f32 v119, v119, v205
    v_mul_f32 v120, v120, v205
    v_mul_f32 v121, v121, v205
    v_mul_f32 v122, v122, v205
    v_mul_f32 v123, v123, v205
    v_cvt_pk_bf16_f32 v206, v112, v113
    v_cvt_pk_bf16_f32 v207, v114, v115
    buffer_store_dwordx2 v[206:207], v213, s[20:23], 0 offen offset:0
    s_nop 0
    v_cvt_pk_bf16_f32 v206, v116, v117
    v_cvt_pk_bf16_f32 v207, v118, v119
    buffer_store_dwordx2 v[206:207], v213, s[20:23], 0 offen offset:16
    s_nop 0
    v_cvt_pk_bf16_f32 v206, v120, v121
    v_cvt_pk_bf16_f32 v207, v122, v123
    buffer_store_dwordx2 v[206:207], v214, s[20:23], 0 offen offset:32
    s_nop 0
    v_mov_b32 v128, v236
    v_mov_b32 v129, v237
    v_mov_b32 v130, v238
    v_mov_b32 v131, v239
    v_mov_b32 v132, v240
    v_mov_b32 v133, v241
    s_lshl_b32 s40, s30, 3
    s_max_u32 s40, s40, 8
    s_sub_u32 s40, s40, 8
    s_sub_u32 s42, s32, s40
    s_min_u32 s47, s32, 8
    s_waitcnt vmcnt(0)
    s_cmp_eq_u32 s30, 0
    s_cbranch_scc1 K2_BGEN
    v_mov_b32 v96, 0
    v_mov_b32 v112, 0
    v_mov_b32 v97, 0
    v_mov_b32 v113, 0
    v_mov_b32 v98, 0
    v_mov_b32 v114, 0
    v_mov_b32 v99, 0
    v_mov_b32 v115, 0
    v_mov_b32 v100, 0
    v_mov_b32 v116, 0
    v_mov_b32 v101, 0
    v_mov_b32 v117, 0
    v_mov_b32 v102, 0
    v_mov_b32 v118, 0
    v_mov_b32 v103, 0
    v_mov_b32 v119, 0
    v_mov_b32 v104, 0
    v_mov_b32 v120, 0
    v_mov_b32 v105, 0
    v_mov_b32 v121, 0
    v_mov_b32 v106, 0
    v_mov_b32 v122, 0
    v_mov_b32 v107, 0
    v_mov_b32 v123, 0
    v_mov_b32 v108, 0
    v_mov_b32 v124, 0
    v_mov_b32 v109, 0
    v_mov_b32 v125, 0
    v_mov_b32 v110, 0
    v_mov_b32 v126, 0
    v_mov_b32 v111, 0
    v_mov_b32 v127, 0
    v_mov_b32 v203, 0
    s_sub_u32 s45, s42, 8
    s_mul_i32 s43, s45, 3072
    s_lshl_b32 s44, s45, 8
    v_add_u32 v13, s43, v208
    v_add_u32 v14, s44, v209
    ds_read_b128 v[136:139], v13 offset:21504
    ds_read_b64 v[140:141], v14 offset:1792
    s_waitcnt lgkmcnt(0)
    v_mfma_f32_32x32x16_bf16 v[48:63], v[136:139], v[128:131], v[96:111]
    v_mfma_f32_32x32x16_bf16 v[48:63], v[140:143], v[132:135], v[48:63]
    ds_read_b128 v[136:139], v13 offset:24576
    ds_read_b64 v[140:141], v14 offset:2048
    ds_read_b128 v[152:155], v13 offset:22528
    ds_read_b128 v[156:159], v13 offset:23552
    s_nop 11
RARE_BINITP:
    v_max3_f32 v204, v48, v49, v50
    v_max3_f32 v205, v51, v52, v53
    v_max3_f32 v204, v204, v54, v55
    v_max3_f32 v205, v205, v56, v57
    v_max3_f32 v204, v204, v58, v59
    v_max3_f32 v205, v205, v60, v61
    v_max3_f32 v204, v204, v62, v63
    v_max_f32 v204, v204, v205
    v_mov_b32 v205, v204
    s_nop 1
    v_permlane32_swap_b32 v204, v205
    v_max_f32 v204, v204, v205
    v_add_f32 v204, 0x42a00000, v204
    v_max_f32 v205, 0, v204
    v_sub_f32 v205, 0, v205
    v_exp_f32 v205, v205
    v_sub_f32 v203, v203, v204
    v_mov_b32 v96, v203
    v_mov_b32 v97, v203
    v_mov_b32 v98, v203
    v_mov_b32 v99, v203
    v_mov_b32 v100, v203
    v_mov_b32 v101, v203
    v_mov_b32 v102, v203
    v_mov_b32 v103, v203
    v_mov_b32 v104, v203
    v_mov_b32 v105, v203
    v_mov_b32 v106, v203
    v_mov_b32 v107, v203
    v_mov_b32 v108, v203
    v_mov_b32 v109, v203
    v_mov_b32 v110, v203
    v_mov_b32 v111, v203
    v_mul_f32 v112, v112, v205
    v_mul_f32 v113, v113, v205
    v_mul_f32 v114, v114, v205
    v_mul_f32 v115, v115, v205
    v_mul_f32 v116, v116, v205
    v_mul_f32 v117, v117, v205
    v_mul_f32 v118, v118, v205
    v_mul_f32 v119, v119, v205
    v_mul_f32 v120, v120, v205
    v_mul_f32 v121, v121, v205
    v_mul_f32 v122, v122, v205
    v_mul_f32 v123, v123, v205
    v_mul_f32 v124, v124, v205
    v_mul_f32 v125, v125, v205
    v_mul_f32 v126, v126, v205
    v_mul_f32 v127, v127, v205
    v_sub_f32 v48, v48, v204
    v_sub_f32 v49, v49, v204
    v_sub_f32 v50, v50, v204
    v_sub_f32 v51, v51, v204
    v_sub_f32 v52, v52, v204
    v_sub_f32 v53, v53, v204
    v_sub_f32 v54, v54, v204
    v_sub_f32 v55, v55, v204
    v_sub_f32 v56, v56, v204
    v_sub_f32 v57, v57, v204
    v_sub_f32 v58, v58, v204
    v_sub_f32 v59, v59, v204
    v_sub_f32 v60, v60, v204
    v_sub_f32 v61, v61, v204
    v_sub_f32 v62, v62, v204
    v_sub_f32 v63, v63, v204
    v_exp_f32 v64, v48
    v_exp_f32 v65, v49
    v_exp_f32 v66, v50
    v_exp_f32 v67, v51
    v_exp_f32 v68, v52
    v_exp_f32 v69, v53
    v_exp_f32 v70, v54
    v_exp_f32 v71, v55
    v_exp_f32 v72, v56
    v_exp_f32 v73, v57
    v_exp_f32 v74, v58
    v_exp_f32 v75, v59
    v_exp_f32 v76, v60
    v_exp_f32 v77, v61
    v_exp_f32 v78, v62
    v_exp_f32 v79, v63
    v_cvt_pk_bf16_f32 v80, v64, v65
    v_cvt_pk_bf16_f32 v81, v66, v67
    v_cvt_pk_bf16_f32 v82, v68, v69
    v_cvt_pk_bf16_f32 v83, v70, v71
    v_cvt_pk_bf16_f32 v84, v72, v73
    v_cvt_pk_bf16_f32 v85, v74, v75
    v_cvt_pk_bf16_f32 v86, v76, v77
    v_cvt_pk_bf16_f32 v87, v78, v79
    s_nop 1
    s_waitcnt lgkmcnt(2)
    v_mfma_f32_32x32x16_bf16 v[32:47], v[136:139], v[128:131], v[96:111]
    v_mfma_f32_32x32x16_bf16 v[32:47], v[140:143], v[132:135], v[32:47]
    ds_read_b128 v[136:139], v13 offset:18432
    ds_read_b64 v[140:141], v14 offset:1536
    s_nop 9
    s_waitcnt lgkmcnt(0)
    s_waitcnt lgkmcnt(2)
    v_cndmask_b32 v32, v202, v32, s[64:65]
    v_cndmask_b32 v33, v202, v33, s[66:67]
    v_cndmask_b32 v34, v202, v34, s[68:69]
    v_cndmask_b32 v35, v202, v35, s[70:71]
    v_cndmask_b32 v36, v202, v36, s[72:73]
    v_cndmask_b32 v37, v202, v37, s[74:75]
    v_cndmask_b32 v38, v202, v38, s[76:77]
    v_cndmask_b32 v39, v202, v39, s[78:79]
    v_cndmask_b32 v40, v202, v40, s[80:81]
    v_cndmask_b32 v41, v202, v41, s[82:83]
    v_cndmask_b32 v42, v202, v42, s[84:85]
    v_cndmask_b32 v43, v202, v43, s[86:87]
    v_cndmask_b32 v44, v202, v44, s[88:89]
    v_cndmask_b32 v45, v202, v45, s[90:91]
    v_cndmask_b32 v46, v202, v46, s[92:93]
    v_cndmask_b32 v47, v202, v47, s[94:95]
    v_mfma_f32_32x32x16_bf16 v[48:63], v[136:139], v[128:131], v[96:111]
    v_exp_f32 v64, v32
    v_exp_f32 v65, v33
    v_exp_f32 v66, v34
    v_exp_f32 v67, v35
    v_mfma_f32_32x32x16_bf16 v[48:63], v[140:143], v[132:135], v[48:63]
    ds_read_b128 v[136:139], v13 offset:15360
    ds_read_b64 v[140:141], v14 offset:1280
    v_exp_f32 v68, v36
    v_exp_f32 v69, v37
    v_exp_f32 v70, v38
    v_exp_f32 v71, v39
    s_waitcnt lgkmcnt(2)
    v_mfma_f32_32x32x16_bf16 v[112:127], v[152:155], v[80:83], v[112:127]
    v_exp_f32 v72, v40
    v_exp_f32 v73, v41
    v_exp_f32 v74, v42
    v_exp_f32 v75, v43
    v_mfma_f32_32x32x16_bf16 v[112:127], v[156:159], v[84:87], v[112:127]
    ds_read_b128 v[152:155], v13 offset:25600
    ds_read_b128 v[156:159], v13 offset:26624
    v_exp_f32 v76, v44
    v_exp_f32 v77, v45
    v_exp_f32 v78, v46
    v_exp_f32 v79, v47
    v_cvt_pk_bf16_f32 v80, v64, v65
    v_cvt_pk_bf16_f32 v81, v66, v67
    v_cvt_pk_bf16_f32 v82, v68, v69
    v_cvt_pk_bf16_f32 v83, v70, v71
    v_cvt_pk_bf16_f32 v84, v72, v73
    v_cvt_pk_bf16_f32 v85, v74, v75
    v_cvt_pk_bf16_f32 v86, v76, v77
    v_cvt_pk_bf16_f32 v87, v78, v79
    s_waitcnt lgkmcnt(2)
    v_mfma_f32_32x32x16_bf16 v[32:47], v[136:139], v[128:131], v[96:111]
    v_exp_f32 v64, v48
    v_exp_f32 v65, v49
    v_exp_f32 v66, v50
    v_exp_f32 v67, v51
    v_mfma_f32_32x32x16_bf16 v[32:47], v[140:143], v[132:135], v[32:47]
    ds_read_b128 v[136:139], v13 offset:12288
    ds_read_b64 v[140:141], v14 offset:1024
    v_exp_f32 v68, v52
    v_exp_f32 v69, v53
    v_exp_f32 v70, v54
    v_exp_f32 v71, v55
    s_waitcnt lgkmcnt(2)
    v_mfma_f32_32x32x16_bf16 v[112:127], v[152:155], v[80:83], v[112:127]
    v_exp_f32 v72, v56
    v_exp_f32 v73, v57
    v_exp_f32 v74, v58
    v_exp_f32 v75, v59
    v_mfma_f32_32x32x16_bf16 v[112:127], v[156:159], v[84:87], v[112:127]
    ds_read_b128 v[152:155], v13 offset:19456
    ds_read_b128 v[156:159], v13 offset:20480
    v_exp_f32 v76, v60
    v_exp_f32 v77, v61
    v_exp_f32 v78, v62
    v_exp_f32 v79, v63
    v_cvt_pk_bf16_f32 v80, v64, v65
    v_cvt_pk_bf16_f32 v81, v66, v67
    v_cvt_pk_bf16_f32 v82, v68, v69
    v_cvt_pk_bf16_f32 v83, v70, v71
    v_cvt_pk_bf16_f32 v84, v72, v73
    v_cvt_pk_bf16_f32 v85, v74, v75
    v_cvt_pk_bf16_f32 v86, v76, v77
    v_cvt_pk_bf16_f32 v87, v78, v79
    s_waitcnt lgkmcnt(2)
    v_mfma_f32_32x32x16_bf16 v[48:63], v[136:139], v[128:131], v[96:111]
    v_exp_f32 v64, v32
    v_exp_f32 v65, v33
    v_exp_f32 v66, v34
    v_exp_f32 v67, v35
    v_mfma_f32_32x32x16_bf16 v[48:63], v[140:143], v[132:135], v[48:63]
    ds_read_b128 v[136:139], v13 offset:9216
    ds_read_b64 v[140:141], v14 offset:768
    v_exp_f32 v68, v36
    v_exp_f32 v69, v37
    v_exp_f32 v70, v38
    v_exp_f32 v71, v39
    s_waitcnt lgkmcnt(2)
    v_mfma_f32_32x32x16_bf16 v[112:127], v[152:155], v[80:83], v[112:127]
    v_exp_f32 v72, v40
    v_exp_f32 v73, v41
    v_exp_f32 v74, v42
    v_exp_f32 v75, v43
    v_mfma_f32_32x32x16_bf16 v[112:127], v[156:159], v[84:87], v[112:127]
    ds_read_b128 v[152:155], v13 offset:16384
    ds_read_b128 v[156:159], v13 offset:17408
    v_exp_f32 v76, v44
    v_exp_f32 v77, v45
    v_exp_f32 v78, v46
    v_exp_f32 v79, v47
    v_cvt_pk_bf16_f32 v80, v64, v65
    v_cvt_pk_bf16_f32 v81, v66, v67
    v_cvt_pk_bf16_f32 v82, v68, v69
    v_cvt_pk_bf16_f32 v83, v70, v71
    v_cvt_pk_bf16_f32 v84, v72, v73
    v_cvt_pk_bf16_f32 v85, v74, v75
    v_cvt_pk_bf16_f32 v86, v76, v77
    v_cvt_pk_bf16_f32 v87, v78, v79
    s_waitcnt lgkmcnt(2)
    v_mfma_f32_32x32x16_bf16 v[32:47], v[136:139], v[128:131], v[96:111]
    v_exp_f32 v64, v48
    v_exp_f32 v65, v49
    v_exp_f32 v66, v50
    v_exp_f32 v67, v51
    v_mfma_f32_32x32x16_bf16 v[32:47], v[140:143], v[132:135], v[32:47]
    ds_read_b128 v[136:139], v13 offset:6144
    ds_read_b64 v[140:141], v14 offset:512
    v_exp_f32 v68, v52
    v_exp_f32 v69, v53
    v_exp_f32 v70, v54
    v_exp_f32 v71, v55
    s_waitcnt lgkmcnt(2)
    v_mfma_f32_32x32x16_bf16 v[112:127], v[152:155], v[80:83], v[112:127]
    v_exp_f32 v72, v56
    v_exp_f32 v73, v57
    v_exp_f32 v74, v58
    v_exp_f32 v75, v59
    v_mfma_f32_32x32x16_bf16 v[112:127], v[156:159], v[84:87], v[112:127]
    ds_read_b128 v[152:155], v13 offset:13312
    ds_read_b128 v[156:159], v13 offset:14336
    v_exp_f32 v76, v60
    v_exp_f32 v77, v61
    v_exp_f32 v78, v62
    v_exp_f32 v79, v63
    v_cvt_pk_bf16_f32 v80, v64, v65
    v_cvt_pk_bf16_f32 v81, v66, v67
    v_cvt_pk_bf16_f32 v82, v68, v69
    v_cvt_pk_bf16_f32 v83, v70, v71
    v_cvt_pk_bf16_f32 v84, v72, v73
    v_cvt_pk_bf16_f32 v85, v74, v75
    v_cvt_pk_bf16_f32 v86, v76, v77
    v_cvt_pk_bf16_f32 v87, v78, v79
    s_waitcnt lgkmcnt(2)
    v_mfma_f32_32x32x16_bf16 v[48:63], v[136:139], v[128:131], v[96:111]
    v_exp_f32 v64, v32
    v_exp_f32 v65, v33
    v_exp_f32 v66, v34
    v_exp_f32 v67, v35
    v_mfma_f32_32x32x16_bf16 v[48:63], v[140:143], v[132:135], v[48:63]
    ds_read_b128 v[136:139], v13 offset:3072
    ds_read_b64 v[140:141], v14 offset:256
    v_exp_f32 v68, v36
    v_exp_f32 v69, v37
    v_exp_f32 v70, v38
    v_exp_f32 v71, v39
    s_waitcnt lgkmcnt(2)
    v_mfma_f32_32x32x16_bf16 v[112:127], v[152:155], v[80:83], v[112:127]
    v_exp_f32 v72, v40
    v_exp_f32 v73, v41
    v_exp_f32 v74, v42
    v_exp_f32 v75, v43
    v_mfma_f32_32x32x16_bf16 v[112:127], v[156:159], v[84:87], v[112:127]
    ds_read_b128 v[152:155], v13 offset:10240
    ds_read_b128 v[156:159], v13 offset:11264
    v_exp_f32 v76, v44
    v_exp_f32 v77, v45
    v_exp_f32 v78, v46
    v_exp_f32 v79, v47
    v_cvt_pk_bf16_f32 v80, v64, v65
    v_cvt_pk_bf16_f32 v81, v66, v67
    v_cvt_pk_bf16_f32 v82, v68, v69
    v_cvt_pk_bf16_f32 v83, v70, v71
    v_cvt_pk_bf16_f32 v84, v72, v73
    v_cvt_pk_bf16_f32 v85, v74, v75
    v_cvt_pk_bf16_f32 v86, v76, v77
    v_cvt_pk_bf16_f32 v87, v78, v79
    s_waitcnt lgkmcnt(2)
    v_mfma_f32_32x32x16_bf16 v[32:47], v[136:139], v[128:131], v[96:111]
    v_exp_f32 v64, v48
    v_exp_f32 v65, v49
    v_exp_f32 v66, v50
    v_exp_f32 v67, v51
    v_mfma_f32_32x32x16_bf16 v[32:47], v[140:143], v[132:135], v[32:47]
    ds_read_b128 v[136:139], v13 offset:0
    ds_read_b64 v[140:141], v14 offset:0
    v_exp_f32 v68, v52
    v_exp_f32 v69, v53
    v_exp_f32 v70, v54
    v_exp_f32 v71, v55
    s_waitcnt lgkmcnt(2)
    v_mfma_f32_32x32x16_bf16 v[112:127], v[152:155], v[80:83], v[112:127]
    v_exp_f32 v72, v56
    v_exp_f32 v73, v57
    v_exp_f32 v74, v58
    v_exp_f32 v75, v59
    v_mfma_f32_32x32x16_bf16 v[112:127], v[156:159], v[84:87], v[112:127]
    ds_read_b128 v[152:155], v13 offset:7168
    ds_read_b128 v[156:159], v13 offset:8192
    v_exp_f32 v76, v60
    v_exp_f32 v77, v61
    v_exp_f32 v78, v62
    v_exp_f32 v79, v63
    v_cvt_pk_bf16_f32 v80, v64, v65
    v_cvt_pk_bf16_f32 v81, v66, v67
    v_cvt_pk_bf16_f32 v82, v68, v69
    v_cvt_pk_bf16_f32 v83, v70, v71
    v_cvt_pk_bf16_f32 v84, v72, v73
    v_cvt_pk_bf16_f32 v85, v74, v75
    v_cvt_pk_bf16_f32 v86, v76, v77
    v_cvt_pk_bf16_f32 v87, v78, v79
    s_waitcnt lgkmcnt(0)
    v_mfma_f32_32x32x16_bf16 v[48:63], v[136:139], v[128:131], v[96:111]
    v_exp_f32 v64, v32
    v_exp_f32 v65, v33
    v_exp_f32 v66, v34
    v_exp_f32 v67, v35
    v_mfma_f32_32x32x16_bf16 v[48:63], v[140:143], v[132:135], v[48:63]
    v_exp_f32 v68, v36
    v_exp_f32 v69, v37
    v_exp_f32 v70, v38
    v_exp_f32 v71, v39
    s_waitcnt lgkmcnt(0)
    v_mfma_f32_32x32x16_bf16 v[112:127], v[152:155], v[80:83], v[112:127]
    v_exp_f32 v72, v40
    v_exp_f32 v73, v41
    v_exp_f32 v74, v42
    v_exp_f32 v75, v43
    v_mfma_f32_32x32x16_bf16 v[112:127], v[156:159], v[84:87], v[112:127]
    ds_read_b128 v[152:155], v13 offset:4096
    ds_read_b128 v[156:159], v13 offset:5120
    v_exp_f32 v76, v44
    v_exp_f32 v77, v45
    v_exp_f32 v78, v46
    v_exp_f32 v79, v47
    v_cvt_pk_bf16_f32 v80, v64, v65
    v_cvt_pk_bf16_f32 v81, v66, v67
    v_cvt_pk_bf16_f32 v82, v68, v69
    v_cvt_pk_bf16_f32 v83, v70, v71
    v_cvt_pk_bf16_f32 v84, v72, v73
    v_cvt_pk_bf16_f32 v85, v74, v75
    v_cvt_pk_bf16_f32 v86, v76, v77
    v_cvt_pk_bf16_f32 v87, v78, v79
    s_waitcnt lgkmcnt(0)
    v_cndmask_b32 v48, v48, v202, s[64:65]
    v_cndmask_b32 v49, v49, v202, s[66:67]
    v_cndmask_b32 v50, v50, v202, s[68:69]
    v_cndmask_b32 v51, v51, v202, s[70:71]
    v_cndmask_b32 v52, v52, v202, s[72:73]
    v_cndmask_b32 v53, v53, v202, s[74:75]
    v_cndmask_b32 v54, v54, v202, s[76:77]
    v_cndmask_b32 v55, v55, v202, s[78:79]
    v_cndmask_b32 v56, v56, v202, s[80:81]
    v_cndmask_b32 v57, v57, v202, s[82:83]
    v_cndmask_b32 v58, v58, v202, s[84:85]
    v_cndmask_b32 v59, v59, v202, s[86:87]
    v_cndmask_b32 v60, v60, v202, s[88:89]
    v_cndmask_b32 v61, v61, v202, s[90:91]
    v_cndmask_b32 v62, v62, v202, s[92:93]
    v_cndmask_b32 v63, v63, v202, s[94:95]
    v_exp_f32 v64, v48
    v_exp_f32 v65, v49
    v_exp_f32 v66, v50
    v_exp_f32 v67, v51
    v_exp_f32 v68, v52
    v_exp_f32 v69, v53
    v_exp_f32 v70, v54
    v_exp_f32 v71, v55
    s_waitcnt lgkmcnt(0)
    v_mfma_f32_32x32x16_bf16 v[112:127], v[152:155], v[80:83], v[112:127]
    v_exp_f32 v72, v56
    v_exp_f32 v73, v57
    v_exp_f32 v74, v58
    v_exp_f32 v75, v59
    v_mfma_f32_32x32x16_bf16 v[112:127], v[156:159], v[84:87], v[112:127]
    ds_read_b128 v[152:155], v13 offset:1024
    ds_read_b128 v[156:159], v13 offset:2048
    v_exp_f32 v76, v60
    v_exp_f32 v77, v61
    v_exp_f32 v78, v62
    v_exp_f32 v79, v63
    v_cvt_pk_bf16_f32 v80, v64, v65
    v_cvt_pk_bf16_f32 v81, v66, v67
    v_cvt_pk_bf16_f32 v82, v68, v69
    v_cvt_pk_bf16_f32 v83, v70, v71
    v_cvt_pk_bf16_f32 v84, v72, v73
    v_cvt_pk_bf16_f32 v85, v74, v75
    v_cvt_pk_bf16_f32 v86, v76, v77
    v_cvt_pk_bf16_f32 v87, v78, v79
    s_waitcnt lgkmcnt(0)
    v_mfma_f32_32x32x16_bf16 v[112:127], v[152:155], v[80:83], v[112:127]
    v_mfma_f32_32x32x16_bf16 v[112:127], v[156:159], v[84:87], v[112:127]
    s_branch K2_BCHK
K2_BGEN:
    v_mov_b32 v96, 0
    v_mov_b32 v112, 0
    v_mov_b32 v97, 0
    v_mov_b32 v113, 0
    v_mov_b32 v98, 0
    v_mov_b32 v114, 0
    v_mov_b32 v99, 0
    v_mov_b32 v115, 0
    v_mov_b32 v100, 0
    v_mov_b32 v116, 0
    v_mov_b32 v101, 0
    v_mov_b32 v117, 0
    v_mov_b32 v102, 0
    v_mov_b32 v118, 0
    v_mov_b32 v103, 0
    v_mov_b32 v119, 0
    v_mov_b32 v104, 0
    v_mov_b32 v120, 0
    v_mov_b32 v105, 0
    v_mov_b32 v121, 0
    v_mov_b32 v106, 0
    v_mov_b32 v122, 0
    v_mov_b32 v107, 0
    v_mov_b32 v123, 0
    v_mov_b32 v108, 0
    v_mov_b32 v124, 0
    v_mov_b32 v109, 0
    v_mov_b32 v125, 0
    v_mov_b32 v110, 0
    v_mov_b32 v126, 0
    v_mov_b32 v111, 0
    v_mov_b32 v127, 0
    v_mov_b32 v203, 0
    s_min_u32 s48, s47, 1
    s_sub_u32 s48, s42, s48
    s_mul_i32 s43, s48, 3072
    s_lshl_b32 s44, s48, 8
    v_add_u32 v13, s43, v208
    v_add_u32 v14, s44, v209
    ds_read_b128 v[136:139], v13 offset:0
    ds_read_b64 v[140:141], v14 offset:0
    ds_read_b128 v[152:155], v13 offset:1024
    ds_read_b128 v[156:159], v13 offset:2048
    s_waitcnt lgkmcnt(2)
    v_mfma_f32_32x32x16_bf16 v[32:47], v[136:139], v[128:131], v[96:111]
    v_mfma_f32_32x32x16_bf16 v[32:47], v[140:143], v[132:135], v[32:47]
    s_nop 11
    s_cmp_eq_u32 s47, 0
    s_cbranch_scc0 K2_B1_F
    v_cndmask_b32 v32, v202, v32, s[64:65]
    v_cndmask_b32 v33, v202, v33, s[66:67]
    v_cndmask_b32 v34, v202, v34, s[68:69]
    v_cndmask_b32 v35, v202, v35, s[70:71]
    v_cndmask_b32 v36, v202, v36, s[72:73]
    v_cndmask_b32 v37, v202, v37, s[74:75]
    v_cndmask_b32 v38, v202, v38, s[76:77]
    v_cndmask_b32 v39, v202, v39, s[78:79]
    v_cndmask_b32 v40, v202, v40, s[80:81]
    v_cndmask_b32 v41, v202, v41, s[82:83]
    v_cndmask_b32 v42, v202, v42, s[84:85]
    v_cndmask_b32 v43, v202, v43, s[86:87]
    v_cndmask_b32 v44, v202, v44, s[88:89]
    v_cndmask_b32 v45, v202, v45, s[90:91]
    v_cndmask_b32 v46, v202, v46, s[92:93]
    v_cndmask_b32 v47, v202, v47, s[94:95]
K2_B1_F:
RARE_BINITF:
    v_max3_f32 v204, v32, v33, v34
    v_max3_f32 v205, v35, v36, v37
    v_max3_f32 v204, v204, v38, v39
    v_max3_f32 v205, v205, v40, v41
    v_max3_f32 v204, v204, v42, v43
    v_max3_f32 v205, v205, v44, v45
    v_max3_f32 v204, v204, v46, v47
    v_max_f32 v204, v204, v205
    v_mov_b32 v205, v204
    s_nop 1
    v_permlane32_swap_b32 v204, v205
    v_max_f32 v204, v204, v205
    v_add_f32 v204, 0x42a00000, v204
    v_max_f32 v205, 0, v204
    v_sub_f32 v205, 0, v205
    v_exp_f32 v205, v205
    v_sub_f32 v203, v203, v204
    v_mov_b32 v96, v203
    v_mov_b32 v97, v203
    v_mov_b32 v98, v203
    v_mov_b32 v99, v203
    v_mov_b32 v100, v203
    v_mov_b32 v101, v203
    v_mov_b32 v102, v203
    v_mov_b32 v103, v203
    v_mov_b32 v104, v203
    v_mov_b32 v105, v203
    v_mov_b32 v106, v203
    v_mov_b32 v107, v203
    v_mov_b32 v108, v203
    v_mov_b32 v109, v203
    v_mov_b32 v110, v203
    v_mov_b32 v111, v203
    v_mul_f32 v112, v112, v205
    v_mul_f32 v113, v113, v205
    v_mul_f32 v114, v114, v205
    v_mul_f32 v115, v115, v205
    v_mul_f32 v116, v116, v205
    v_mul_f32 v117, v117, v205
    v_mul_f32 v118, v118, v205
    v_mul_f32 v119, v119, v205
    v_mul_f32 v120, v120, v205
    v_mul_f32 v121, v121, v205
    v_mul_f32 v122, v122, v205
    v_mul_f32 v123, v123, v205
    v_mul_f32 v124, v124, v205
    v_mul_f32 v125, v125, v205
    v_mul_f32 v126, v126, v205
    v_mul_f32 v127, v127, v205
    v_sub_f32 v32, v32, v204
    v_sub_f32 v33, v33, v204
    v_sub_f32 v34, v34, v204
    v_sub_f32 v35, v35, v204
    v_sub_f32 v36, v36, v204
    v_sub_f32 v37, v37, v204
    v_sub_f32 v38, v38, v204
    v_sub_f32 v39, v39, v204
    v_sub_f32 v40, v40, v204
    v_sub_f32 v41, v41, v204
    v_sub_f32 v42, v42, v204
    v_sub_f32 v43, v43, v204
    v_sub_f32 v44, v44, v204
    v_sub_f32 v45, v45, v204
    v_sub_f32 v46, v46, v204
    v_sub_f32 v47, v47, v204
    v_exp_f32 v64, v32
    v_exp_f32 v65, v33
    v_exp_f32 v66, v34
    v_exp_f32 v67, v35
    v_exp_f32 v68, v36
    v_exp_f32 v69, v37
    v_exp_f32 v70, v38
    v_exp_f32 v71, v39
    v_exp_f32 v72, v40
    v_exp_f32 v73, v41
    v_exp_f32 v74, v42
    v_exp_f32 v75, v43
    v_exp_f32 v76, v44
    v_exp_f32 v77, v45
    v_exp_f32 v78, v46
    v_exp_f32 v79, v47
    v_cvt_pk_bf16_f32 v80, v64, v65
    v_cvt_pk_bf16_f32 v81, v66, v67
    v_cvt_pk_bf16_f32 v82, v68, v69
    v_cvt_pk_bf16_f32 v83, v70, v71
    v_cvt_pk_bf16_f32 v84, v72, v73
    v_cvt_pk_bf16_f32 v85, v74, v75
    v_cvt_pk_bf16_f32 v86, v76, v77
    v_cvt_pk_bf16_f32 v87, v78, v79
    s_nop 1
    s_waitcnt lgkmcnt(0)
    v_mfma_f32_32x32x16_bf16 v[112:127], v[152:155], v[80:83], v[112:127]
    v_mfma_f32_32x32x16_bf16 v[112:127], v[156:159], v[84:87], v[112:127]
    s_cmp_eq_u32 s47, 0
    s_cbranch_scc1 K2_BDONE_F
    s_mov_b32 s45, 0
K2_BL_F:
    s_sub_u32 s48, s42, s45
    s_sub_u32 s48, s48, 1
    s_cmp_eq_u32 s45, 0
    s_cselect_b32 s48, s42, s48
    s_mul_i32 s43, s48, 3072
    s_lshl_b32 s44, s48, 8
    v_add_u32 v13, s43, v208
    v_add_u32 v14, s44, v209
    ds_read_b128 v[136:139], v13 offset:0
    ds_read_b64 v[140:141], v14 offset:0
    ds_read_b128 v[152:155], v13 offset:1024
    ds_read_b128 v[156:159], v13 offset:2048
    s_waitcnt lgkmcnt(2)
    v_mfma_f32_32x32x16_bf16 v[32:47], v[136:139], v[128:131], v[96:111]
    v_mfma_f32_32x32x16_bf16 v[32:47], v[140:143], v[132:135], v[32:47]
    s_nop 11
    s_cmp_eq_u32 s45, 0
    s_cbranch_scc0 K2_BND_F
    v_cndmask_b32 v32, v202, v32, s[64:65]
    v_cndmask_b32 v33, v202, v33, s[66:67]
    v_cndmask_b32 v34, v202, v34, s[68:69]
    v_cndmask_b32 v35, v202, v35, s[70:71]
    v_cndmask_b32 v36, v202, v36, s[72:73]
    v_cndmask_b32 v37, v202, v37, s[74:75]
    v_cndmask_b32 v38, v202, v38, s[76:77]
    v_cndmask_b32 v39, v202, v39, s[78:79]
    v_cndmask_b32 v40, v202, v40, s[80:81]
    v_cndmask_b32 v41, v202, v41, s[82:83]
    v_cndmask_b32 v42, v202, v42, s[84:85]
    v_cndmask_b32 v43, v202, v43, s[86:87]
    v_cndmask_b32 v44, v202, v44, s[88:89]
    v_cndmask_b32 v45, v202, v45, s[90:91]
    v_cndmask_b32 v46, v202, v46, s[92:93]
    v_cndmask_b32 v47, v202, v47, s[94:95]
K2_BND_F:
    s_cmp_eq_u32 s45, 7
    s_cbranch_scc0 K2_BNM_F
    v_cndmask_b32 v32, v32, v202, s[64:65]
    v_cndmask_b32 v33, v33, v202, s[66:67]
    v_cndmask_b32 v34, v34, v202, s[68:69]
    v_cndmask_b32 v35, v35, v202, s[70:71]
    v_cndmask_b32 v36, v36, v202, s[72:73]
    v_cndmask_b32 v37, v37, v202, s[74:75]
    v_cndmask_b32 v38, v38, v202, s[76:77]
    v_cndmask_b32 v39, v39, v202, s[78:79]
    v_cndmask_b32 v40, v40, v202, s[80:81]
    v_cndmask_b32 v41, v41, v202, s[82:83]
    v_cndmask_b32 v42, v42, v202, s[84:85]
    v_cndmask_b32 v43, v43, v202, s[86:87]
    v_cndmask_b32 v44, v44, v202, s[88:89]
    v_cndmask_b32 v45, v45, v202, s[90:91]
    v_cndmask_b32 v46, v46, v202, s[92:93]
    v_cndmask_b32 v47, v47, v202, s[94:95]
K2_BNM_F:
    v_exp_f32 v64, v32
    v_exp_f32 v65, v33
    v_exp_f32 v66, v34
    v_exp_f32 v67, v35
    v_exp_f32 v68, v36
    v_exp_f32 v69, v37
    v_exp_f32 v70, v38
    v_exp_f32 v71, v39
    v_exp_f32 v72, v40
    v_exp_f32 v73, v41
    v_exp_f32 v74, v42
    v_exp_f32 v75, v43
    v_exp_f32 v76, v44
    v_exp_f32 v77, v45
    v_exp_f32 v78, v46
    v_exp_f32 v79, v47
    v_cvt_pk_bf16_f32 v80, v64, v65
    v_cvt_pk_bf16_f32 v81, v66, v67
    v_cvt_pk_bf16_f32 v82, v68, v69
    v_cvt_pk_bf16_f32 v83, v70, v71
    v_cvt_pk_bf16_f32 v84, v72, v73
    v_cvt_pk_bf16_f32 v85, v74, v75
    v_cvt_pk_bf16_f32 v86, v76, v77
    v_cvt_pk_bf16_f32 v87, v78, v79
    s_waitcnt lgkmcnt(0)
    v_mfma_f32_32x32x16_bf16 v[112:127], v[152:155], v[80:83], v[112:127]
    v_mfma_f32_32x32x16_bf16 v[112:127], v[156:159], v[84:87], v[112:127]
    s_add_u32 s45, s45, 1
    s_cmp_lt_u32 s45, s47
    s_cbranch_scc1 K2_BL_F
K2_BDONE_F:
K2_BCHK:
    s_nop 15
    v_cmp_ngt_f32 vcc, 0x53800000, v120
    s_cbranch_vccnz K2_BSLOW
K2_BFIN:
    s_nop 15
    v_mov_b32 v204, v120
    v_mov_b32 v205, v120
    s_nop 1
    v_permlane32_swap_b32 v204, v205
    v_rcp_f32 v205, v205
    s_nop 0
    v_mul_f32 v112, v112, v205
    v_mul_f32 v113, v113, v205
    v_mul_f32 v114, v114, v205
    v_mul_f32 v115, v115, v205
    v_mul_f32 v116, v116, v205
    v_mul_f32 v117, v117, v205
    v_mul_f32 v118, v118, v205
    v_mul_f32 v119, v119, v205
    v_mul_f32 v120, v120, v205
    v_mul_f32 v121, v121, v205
    v_mul_f32 v122, v122, v205
    v_mul_f32 v123, v123, v205
    v_cvt_pk_bf16_f32 v206, v112, v113
    v_cvt_pk_bf16_f32 v207, v114, v115
    buffer_store_dwordx2 v[206:207], v213, s[20:23], 0 offen offset:1280
    s_nop 0
    v_cvt_pk_bf16_f32 v206, v116, v117
    v_cvt_pk_bf16_f32 v207, v118, v119
    buffer_store_dwordx2 v[206:207], v213, s[20:23], 0 offen offset:1296
    s_nop 0
    v_cvt_pk_bf16_f32 v206, v120, v121
    v_cvt_pk_bf16_f32 v207, v122, v123
    buffer_store_dwordx2 v[206:207], v214, s[20:23], 0 offen offset:1312
    s_nop 0
K2_END:
    s_endpgm
K2_BSLOW:
    v_mov_b32 v96, 0
    v_mov_b32 v112, 0
    v_mov_b32 v97, 0
    v_mov_b32 v113, 0
    v_mov_b32 v98, 0
    v_mov_b32 v114, 0
    v_mov_b32 v99, 0
    v_mov_b32 v115, 0
    v_mov_b32 v100, 0
    v_mov_b32 v116, 0
    v_mov_b32 v101, 0
    v_mov_b32 v117, 0
    v_mov_b32 v102, 0
    v_mov_b32 v118, 0
    v_mov_b32 v103, 0
    v_mov_b32 v119, 0
    v_mov_b32 v104, 0
    v_mov_b32 v120, 0
    v_mov_b32 v105, 0
    v_mov_b32 v121, 0
    v_mov_b32 v106, 0
    v_mov_b32 v122, 0
    v_mov_b32 v107, 0
    v_mov_b32 v123, 0
    v_mov_b32 v108, 0
    v_mov_b32 v124, 0
    v_mov_b32 v109, 0
    v_mov_b32 v125, 0
    v_mov_b32 v110, 0
    v_mov_b32 v126, 0
    v_mov_b32 v111, 0
    v_mov_b32 v127, 0
    v_mov_b32 v203, 0
    s_min_u32 s48, s47, 1
    s_sub_u32 s48, s42, s48
    s_mul_i32 s43, s48, 3072
    s_lshl_b32 s44, s48, 8
    v_add_u32 v13, s43, v208
    v_add_u32 v14, s44, v209
    ds_read_b128 v[136:139], v13 offset:0
    ds_read_b64 v[140:141], v14 offset:0
    ds_read_b128 v[152:155], v13 offset:1024
    ds_read_b128 v[156:159], v13 offset:2048
    s_waitcnt lgkmcnt(2)
    v_mfma_f32_32x32x16_bf16 v[32:47], v[136:139], v[128:131], v[96:111]
    v_mfma_f32_32x32x16_bf16 v[32:47], v[140:143], v[132:135], v[32:47]
    s_nop 11
    s_cmp_eq_u32 s47, 0
    s_cbranch_scc0 K2_B1_S
    v_cndmask_b32 v32, v202, v32, s[64:65]
    v_cndmask_b32 v33, v202, v33, s[66:67]
    v_cndmask_b32 v34, v202, v34, s[68:69]
    v_cndmask_b32 v35, v202, v35, s[70:71]
    v_cndmask_b32 v36, v202, v36, s[72:73]
    v_cndmask_b32 v37, v202, v37, s[74:75]
    v_cndmask_b32 v38, v202, v38, s[76:77]
    v_cndmask_b32 v39, v202, v39, s[78:79]
    v_cndmask_b32 v40, v202, v40, s[80:81]
    v_cndmask_b32 v41, v202, v41, s[82:83]
    v_cndmask_b32 v42, v202, v42, s[84:85]
    v_cndmask_b32 v43, v202, v43, s[86:87]
    v_cndmask_b32 v44, v202, v44, s[88:89]
    v_cndmask_b32 v45, v202, v45, s[90:91]
    v_cndmask_b32 v46, v202, v46, s[92:93]
    v_cndmask_b32 v47, v202, v47, s[94:95]
K2_B1_S:
RARE_BINITS:
    v_max3_f32 v204, v32, v33, v34
    v_max3_f32 v205, v35, v36, v37
    v_max3_f32 v204, v204, v38, v39
    v_max3_f32 v205, v205, v40, v41
    v_max3_f32 v204, v204, v42, v43
    v_max3_f32 v205, v205, v44, v45
    v_max3_f32 v204, v204, v46, v47
    v_max_f32 v204, v204, v205
    v_mov_b32 v205, v204
    s_nop 1
    v_permlane32_swap_b32 v204, v205
    v_max_f32 v204, v204, v205
    v_add_f32 v204, 0x42a00000, v204
    v_max_f32 v205, 0, v204
    v_sub_f32 v205, 0, v205
    v_exp_f32 v205, v205
    v_sub_f32 v203, v203, v204
    v_mov_b32 v96, v203
    v_mov_b32 v97, v203
    v_mov_b32 v98, v203
    v_mov_b32 v99, v203
    v_mov_b32 v100, v203
    v_mov_b32 v101, v203
    v_mov_b32 v102, v203
    v_mov_b32 v103, v203
    v_mov_b32 v104, v203
    v_mov_b32 v105, v203
    v_mov_b32 v106, v203
    v_mov_b32 v107, v203
    v_mov_b32 v108, v203
    v_mov_b32 v109, v203
    v_mov_b32 v110, v203
    v_mov_b32 v111, v203
    v_mul_f32 v112, v112, v205
    v_mul_f32 v113, v113, v205
    v_mul_f32 v114, v114, v205
    v_mul_f32 v115, v115, v205
    v_mul_f32 v116, v116, v205
    v_mul_f32 v117, v117, v205
    v_mul_f32 v118, v118, v205
    v_mul_f32 v119, v119, v205
    v_mul_f32 v120, v120, v205
    v_mul_f32 v121, v121, v205
    v_mul_f32 v122, v122, v205
    v_mul_f32 v123, v123, v205
    v_mul_f32 v124, v124, v205
    v_mul_f32 v125, v125, v205
    v_mul_f32 v126, v126, v205
    v_mul_f32 v127, v127, v205
    v_sub_f32 v32, v32, v204
    v_sub_f32 v33, v33, v204
    v_sub_f32 v34, v34, v204
    v_sub_f32 v35, v35, v204
    v_sub_f32 v36, v36, v204
    v_sub_f32 v37, v37, v204
    v_sub_f32 v38, v38, v204
    v_sub_f32 v39, v39, v204
    v_sub_f32 v40, v40, v204
    v_sub_f32 v41, v41, v204
    v_sub_f32 v42, v42, v204
    v_sub_f32 v43, v43, v204
    v_sub_f32 v44, v44, v204
    v_sub_f32 v45, v45, v204
    v_sub_f32 v46, v46, v204
    v_sub_f32 v47, v47, v204
    v_exp_f32 v64, v32
    v_exp_f32 v65, v33
    v_exp_f32 v66, v34
    v_exp_f32 v67, v35
    v_exp_f32 v68, v36
    v_exp_f32 v69, v37
    v_exp_f32 v70, v38
    v_exp_f32 v71, v39
    v_exp_f32 v72, v40
    v_exp_f32 v73, v41
    v_exp_f32 v74, v42
    v_exp_f32 v75, v43
    v_exp_f32 v76, v44
    v_exp_f32 v77, v45
    v_exp_f32 v78, v46
    v_exp_f32 v79, v47
    v_cvt_pk_bf16_f32 v80, v64, v65
    v_cvt_pk_bf16_f32 v81, v66, v67
    v_cvt_pk_bf16_f32 v82, v68, v69
    v_cvt_pk_bf16_f32 v83, v70, v71
    v_cvt_pk_bf16_f32 v84, v72, v73
    v_cvt_pk_bf16_f32 v85, v74, v75
    v_cvt_pk_bf16_f32 v86, v76, v77
    v_cvt_pk_bf16_f32 v87, v78, v79
    s_nop 1
    s_waitcnt lgkmcnt(0)
    v_mfma_f32_32x32x16_bf16 v[112:127], v[152:155], v[80:83], v[112:127]
    v_mfma_f32_32x32x16_bf16 v[112:127], v[156:159], v[84:87], v[112:127]
    s_cmp_eq_u32 s47, 0
    s_cbranch_scc1 K2_BDONE_S
    s_mov_b32 s45, 0
K2_BL_S:
    s_sub_u32 s48, s42, s45
    s_sub_u32 s48, s48, 1
    s_cmp_eq_u32 s45, 0
    s_cselect_b32 s48, s42, s48
    s_mul_i32 s43, s48, 3072
    s_lshl_b32 s44, s48, 8
    v_add_u32 v13, s43, v208
    v_add_u32 v14, s44, v209
    ds_read_b128 v[136:139], v13 offset:0
    ds_read_b64 v[140:141], v14 offset:0
    ds_read_b128 v[152:155], v13 offset:1024
    ds_read_b128 v[156:159], v13 offset:2048
    s_waitcnt lgkmcnt(2)
    v_mfma_f32_32x32x16_bf16 v[32:47], v[136:139], v[128:131], v[96:111]
    v_mfma_f32_32x32x16_bf16 v[32:47], v[140:143], v[132:135], v[32:47]
    s_nop 11
    s_cmp_eq_u32 s45, 0
    s_cbranch_scc0 K2_BND_S
    v_cndmask_b32 v32, v202, v32, s[64:65]
    v_cndmask_b32 v33, v202, v33, s[66:67]
    v_cndmask_b32 v34, v202, v34, s[68:69]
    v_cndmask_b32 v35, v202, v35, s[70:71]
    v_cndmask_b32 v36, v202, v36, s[72:73]
    v_cndmask_b32 v37, v202, v37, s[74:75]
    v_cndmask_b32 v38, v202, v38, s[76:77]
    v_cndmask_b32 v39, v202, v39, s[78:79]
    v_cndmask_b32 v40, v202, v40, s[80:81]
    v_cndmask_b32 v41, v202, v41, s[82:83]
    v_cndmask_b32 v42, v202, v42, s[84:85]
    v_cndmask_b32 v43, v202, v43, s[86:87]
    v_cndmask_b32 v44, v202, v44, s[88:89]
    v_cndmask_b32 v45, v202, v45, s[90:91]
    v_cndmask_b32 v46, v202, v46, s[92:93]
    v_cndmask_b32 v47, v202, v47, s[94:95]
K2_BND_S:
    s_cmp_eq_u32 s45, 7
    s_cbranch_scc0 K2_BNM_S
    v_cndmask_b32 v32, v32, v202, s[64:65]
    v_cndmask_b32 v33, v33, v202, s[66:67]
    v_cndmask_b32 v34, v34, v202, s[68:69]
    v_cndmask_b32 v35, v35, v202, s[70:71]
    v_cndmask_b32 v36, v36, v202, s[72:73]
    v_cndmask_b32 v37, v37, v202, s[74:75]
    v_cndmask_b32 v38, v38, v202, s[76:77]
    v_cndmask_b32 v39, v39, v202, s[78:79]
    v_cndmask_b32 v40, v40, v202, s[80:81]
    v_cndmask_b32 v41, v41, v202, s[82:83]
    v_cndmask_b32 v42, v42, v202, s[84:85]
    v_cndmask_b32 v43, v43, v202, s[86:87]
    v_cndmask_b32 v44, v44, v202, s[88:89]
    v_cndmask_b32 v45, v45, v202, s[90:91]
    v_cndmask_b32 v46, v46, v202, s[92:93]
    v_cndmask_b32 v47, v47, v202, s[94:95]
K2_BNM_S:
    v_exp_f32 v64, v32
    v_exp_f32 v65, v33
    v_exp_f32 v66, v34
    v_exp_f32 v67, v35
    v_exp_f32 v68, v36
    v_exp_f32 v69, v37
    v_exp_f32 v70, v38
    v_exp_f32 v71, v39
    v_exp_f32 v72, v40
    v_exp_f32 v73, v41
    v_exp_f32 v74, v42
    v_exp_f32 v75, v43
    v_exp_f32 v76, v44
    v_exp_f32 v77, v45
    v_exp_f32 v78, v46
    v_exp_f32 v79, v47
    v_cvt_pk_bf16_f32 v80, v64, v65
    v_cvt_pk_bf16_f32 v81, v66, v67
    v_cvt_pk_bf16_f32 v82, v68, v69
    v_cvt_pk_bf16_f32 v83, v70, v71
    v_cvt_pk_bf16_f32 v84, v72, v73
    v_cvt_pk_bf16_f32 v85, v74, v75
    v_cvt_pk_bf16_f32 v86, v76, v77
    v_cvt_pk_bf16_f32 v87, v78, v79
    v_or3_b32 v204, v80, v81, v82
    v_or3_b32 v205, v83, v84, v85
    v_or3_b32 v204, v204, v86, v87
    v_or_b32 v204, v204, v205
    v_and_b32 v204, 0x40004000, v204
    v_cmp_ne_u32 vcc, 0, v204
    s_cbranch_vccnz RARE_BM
BACK_BM:
    s_waitcnt lgkmcnt(0)
    v_mfma_f32_32x32x16_bf16 v[112:127], v[152:155], v[80:83], v[112:127]
    v_mfma_f32_32x32x16_bf16 v[112:127], v[156:159], v[84:87], v[112:127]
    s_add_u32 s45, s45, 1
    s_cmp_lt_u32 s45, s47
    s_cbranch_scc1 K2_BL_S
K2_BDONE_S:
    s_branch K2_BFIN
K2_SLOW:
    v_mov_b32 v112, v216
    v_mov_b32 v96, v232
    v_mov_b32 v113, v217
    v_mov_b32 v97, v232
    v_mov_b32 v114, v218
    v_mov_b32 v98, v232
    v_mov_b32 v115, v219
    v_mov_b32 v99, v232
    v_mov_b32 v116, v220
    v_mov_b32 v100, v232
    v_mov_b32 v117, v221
    v_mov_b32 v101, v232
    v_mov_b32 v118, v222
    v_mov_b32 v102, v232
    v_mov_b32 v119, v223
    v_mov_b32 v103, v232
    v_mov_b32 v120, v224
    v_mov_b32 v104, v232
    v_mov_b32 v121, v225
    v_mov_b32 v105, v232
    v_mov_b32 v122, v226
    v_mov_b32 v106, v232
    v_mov_b32 v123, v227
    v_mov_b32 v107, v232
    v_mov_b32 v124, v228
    v_mov_b32 v108, v232
    v_mov_b32 v125, v229
    v_mov_b32 v109, v232
    v_mov_b32 v126, v230
    v_mov_b32 v110, v232
    v_mov_b32 v127, v231
    v_mov_b32 v111, v232
    v_mov_b32 v203, v232
    ds_read_b128 v[136:139], v208 offset:0
    ds_read_b64 v[140:141], v209 offset:0
    v_mov_b32 v80, 0
    v_mov_b32 v81, 0
    v_mov_b32 v82, 0
    v_mov_b32 v83, 0
    v_mov_b32 v84, 0
    v_mov_b32 v85, 0
    v_mov_b32 v86, 0
    v_mov_b32 v87, 0
    s_waitcnt lgkmcnt(0)
    v_mfma_f32_32x32x16_bf16 v[32:47], v[136:139], v[128:131], v[96:111]
    v_mfma_f32_32x32x16_bf16 v[32:47], v[140:143], v[132:135], v[32:47]
    ds_read_b128 v[136:139], v208 offset:3072
    ds_read_b64 v[140:141], v209 offset:256
    ds_read_b128 v[152:155], v208 offset:1024
    ds_read_b128 v[156:159], v208 offset:2048
    s_nop 9
    s_mov_b32 s41, 0
    v_mov_b32 v13, v208
    v_mov_b32 v14, v209
K2_BLK:
    s_waitcnt lgkmcnt(2)
    v_mfma_f32_32x32x16_bf16 v[48:63], v[136:139], v[128:131], v[96:111]
    v_exp_f32 v64, v32
    v_exp_f32 v65, v33
    v_exp_f32 v66, v34
    v_exp_f32 v67, v35
    v_mfma_f32_32x32x16_bf16 v[48:63], v[140:143], v[132:135], v[48:63]
    ds_read_b128 v[136:139], v13 offset:6144
    ds_read_b64 v[140:141], v14 offset:512
    v_exp_f32 v68, v36
    v_exp_f32 v69, v37
    v_exp_f32 v70, v38
    v_exp_f32 v71, v39
    s_waitcnt lgkmcnt(2)
    v_mfma_f32_32x32x16_bf16 v[112:127], v[152:155], v[80:83], v[112:127]
    v_exp_f32 v72, v40
    v_exp_f32 v73, v41
    v_exp_f32 v74, v42
    v_exp_f32 v75, v43
    v_mfma_f32_32x32x16_bf16 v[112:127], v[156:159], v[84:87], v[112:127]
    ds_read_b128 v[152:155], v13 offset:1024
    ds_read_b128 v[156:159], v13 offset:2048
    v_exp_f32 v76, v44
    v_exp_f32 v77, v45
    v_exp_f32 v78, v46
    v_exp_f32 v79, v47
    v_cvt_pk_bf16_f32 v80, v64, v65
    v_cvt_pk_bf16_f32 v81, v66, v67
    v_cvt_pk_bf16_f32 v82, v68, v69
    v_cvt_pk_bf16_f32 v83, v70, v71
    v_cvt_pk_bf16_f32 v84, v72, v73
    v_cvt_pk_bf16_f32 v85, v74, v75
    v_cvt_pk_bf16_f32 v86, v76, v77
    v_cvt_pk_bf16_f32 v87, v78, v79
    v_or3_b32 v204, v80, v81, v82
    v_or3_b32 v205, v83, v84, v85
    v_or3_b32 v204, v204, v86, v87
    v_or_b32 v204, v204, v205
    v_and_b32 v204, 0x40004000, v204
    v_cmp_ne_u32 vcc, 0, v204
    s_cbranch_vccnz RARE_A0
BACK_A0:
    s_waitcnt lgkmcnt(2)
    v_mfma_f32_32x32x16_bf16 v[32:47], v[136:139], v[128:131], v[96:111]
    v_exp_f32 v64, v48
    v_exp_f32 v65, v49
    v_exp_f32 v66, v50
    v_exp_f32 v67, v51
    v_mfma_f32_32x32x16_bf16 v[32:47], v[140:143], v[132:135], v[32:47]
    ds_read_b128 v[136:139], v13 offset:9216
    ds_read_b64 v[140:141], v14 offset:768
    v_exp_f32 v68, v52
    v_exp_f32 v69, v53
    v_exp_f32 v70, v54
    v_exp_f32 v71, v55
    s_waitcnt lgkmcnt(2)
    v_mfma_f32_32x32x16_bf16 v[112:127], v[152:155], v[80:83], v[112:127]
    v_exp_f32 v72, v56
    v_exp_f32 v73, v57
    v_exp_f32 v74, v58
    v_exp_f32 v75, v59
    v_mfma_f32_32x32x16_bf16 v[112:127], v[156:159], v[84:87], v[112:127]
    ds_read_b128 v[152:155], v13 offset:4096
    ds_read_b128 v[156:159], v13 offset:5120
    v_exp_f32 v76, v60
    v_exp_f32 v77, v61
    v_exp_f32 v78, v62
    v_exp_f32 v79, v63
    v_cvt_pk_bf16_f32 v80, v64, v65
    v_cvt_pk_bf16_f32 v81, v66, v67
    v_cvt_pk_bf16_f32 v82, v68, v69
    v_cvt_pk_bf16_f32 v83, v70, v71
    v_cvt_pk_bf16_f32 v84, v72, v73
    v_cvt_pk_bf16_f32 v85, v74, v75
    v_cvt_pk_bf16_f32 v86, v76, v77
    v_cvt_pk_bf16_f32 v87, v78, v79
    v_or3_b32 v204, v80, v81, v82
    v_or3_b32 v205, v83, v84, v85
    v_or3_b32 v204, v204, v86, v87
    v_or_b32 v204, v204, v205
    v_and_b32 v204, 0x40004000, v204
    v_cmp_ne_u32 vcc, 0, v204
    s_cbranch_vccnz RARE_A1
BACK_A1:
    v_add_u32 v13, 6144, v13
    v_add_u32 v14, 512, v14
    s_add_u32 s41, s41, 1
    s_cmp_lt_u32 s41, 8
    s_cbranch_scc1 K2_BLK
    s_waitcnt lgkmcnt(0)
    v_mfma_f32_32x32x16_bf16 v[112:127], v[152:155], v[80:83], v[112:127]
    v_mfma_f32_32x32x16_bf16 v[112:127], v[156:159], v[84:87], v[112:127]
    s_branch K2_TILE_DONE
RARE_BM:
    v_max3_f32 v204, v32, v33, v34
    v_max3_f32 v205, v35, v36, v37
    v_max3_f32 v204, v204, v38, v39
    v_max3_f32 v205, v205, v40, v41
    v_max3_f32 v204, v204, v42, v43
    v_max3_f32 v205, v205, v44, v45
    v_max3_f32 v204, v204, v46, v47
    v_max_f32 v204, v204, v205
    v_mov_b32 v205, v204
    s_nop 1
    v_permlane32_swap_b32 v204, v205
    v_max_f32 v204, v204, v205
    v_add_f32 v204, 0x42a00000, v204
    v_max_f32 v204, 0, v204
    v_max_f32 v205, 0, v204
    v_sub_f32 v205, 0, v205
    v_exp_f32 v205, v205
    v_sub_f32 v203, v203, v204
    v_mov_b32 v96, v203
    v_mov_b32 v97, v203
    v_mov_b32 v98, v203
    v_mov_b32 v99, v203
    v_mov_b32 v100, v203
    v_mov_b32 v101, v203
    v_mov_b32 v102, v203
    v_mov_b32 v103, v203
    v_mov_b32 v104, v203
    v_mov_b32 v105, v203
    v_mov_b32 v106, v203
    v_mov_b32 v107, v203
    v_mov_b32 v108, v203
    v_mov_b32 v109, v203
    v_mov_b32 v110, v203
    v_mov_b32 v111, v203
    v_mul_f32 v112, v112, v205
    v_mul_f32 v113, v113, v205
    v_mul_f32 v114, v114, v205
    v_mul_f32 v115, v115, v205
    v_mul_f32 v116, v116, v205
    v_mul_f32 v117, v117, v205
    v_mul_f32 v118, v118, v205
    v_mul_f32 v119, v119, v205
    v_mul_f32 v120, v120, v205
    v_mul_f32 v121, v121, v205
    v_mul_f32 v122, v122, v205
    v_mul_f32 v123, v123, v205
    v_mul_f32 v124, v124, v205
    v_mul_f32 v125, v125, v205
    v_mul_f32 v126, v126, v205
    v_mul_f32 v127, v127, v205
    v_sub_f32 v32, v32, v204
    v_sub_f32 v33, v33, v204
    v_sub_f32 v34, v34, v204
    v_sub_f32 v35, v35, v204
    v_sub_f32 v36, v36, v204
    v_sub_f32 v37, v37, v204
    v_sub_f32 v38, v38, v204
    v_sub_f32 v39, v39, v204
    v_sub_f32 v40, v40, v204
    v_sub_f32 v41, v41, v204
    v_sub_f32 v42, v42, v204
    v_sub_f32 v43, v43, v204
    v_sub_f32 v44, v44, v204
    v_sub_f32 v45, v45, v204
    v_sub_f32 v46, v46, v204
    v_sub_f32 v47, v47, v204
    v_exp_f32 v64, v32
    v_exp_f32 v65, v33
    v_exp_f32 v66, v34
    v_exp_f32 v67, v35
    v_exp_f32 v68, v36
    v_exp_f32 v69, v37
    v_exp_f32 v70, v38
    v_exp_f32 v71, v39
    v_exp_f32 v72, v40
    v_exp_f32 v73, v41
    v_exp_f32 v74, v42
    v_exp_f32 v75, v43
    v_exp_f32 v76, v44
    v_exp_f32 v77, v45
    v_exp_f32 v78, v46
    v_exp_f32 v79, v47
    v_cvt_pk_bf16_f32 v80, v64, v65
    v_cvt_pk_bf16_f32 v81, v66, v67
    v_cvt_pk_bf16_f32 v82, v68, v69
    v_cvt_pk_bf16_f32 v83, v70, v71
    v_cvt_pk_bf16_f32 v84, v72, v73
    v_cvt_pk_bf16_f32 v85, v74, v75
    v_cvt_pk_bf16_f32 v86, v76, v77
    v_cvt_pk_bf16_f32 v87, v78, v79
    s_nop 1
    s_branch BACK_BM
RARE_A0:
    v_max3_f32 v204, v32, v33, v34
    v_max3_f32 v205, v35, v36, v37
    v_max3_f32 v204, v204, v38, v39
    v_max3_f32 v205, v205, v40, v41
    v_max3_f32 v204, v204, v42, v43
    v_max3_f32 v205, v205, v44, v45
    v_max3_f32 v204, v204, v46, v47
    v_max_f32 v204, v204, v205
    v_mov_b32 v205, v204
    s_nop 1
    v_permlane32_swap_b32 v204, v205
    v_max_f32 v204, v204, v205
    v_add_f32 v204, 0x42a00000, v204
    v_max_f32 v204, 0, v204
    v_max_f32 v205, 0, v204
    v_sub_f32 v205, 0, v205
    v_exp_f32 v205, v205
    v_sub_f32 v203, v203, v204
    v_mov_b32 v96, v203
    v_mov_b32 v97, v203
    v_mov_b32 v98, v203
    v_mov_b32 v99, v203
    v_mov_b32 v100, v203
    v_mov_b32 v101, v203
    v_mov_b32 v102, v203
    v_mov_b32 v103, v203
    v_mov_b32 v104, v203
    v_mov_b32 v105, v203
    v_mov_b32 v106, v203
    v_mov_b32 v107, v203
    v_mov_b32 v108, v203
    v_mov_b32 v109, v203
    v_mov_b32 v110, v203
    v_mov_b32 v111, v203
    v_mul_f32 v112, v112, v205
    v_mul_f32 v113, v113, v205
    v_mul_f32 v114, v114, v205
    v_mul_f32 v115, v115, v205
    v_mul_f32 v116, v116, v205
    v_mul_f32 v117, v117, v205
    v_mul_f32 v118, v118, v205
    v_mul_f32 v119, v119, v205
    v_mul_f32 v120, v120, v205
    v_mul_f32 v121, v121, v205
    v_mul_f32 v122, v122, v205
    v_mul_f32 v123, v123, v205
    v_mul_f32 v124, v124, v205
    v_mul_f32 v125, v125, v205
    v_mul_f32 v126, v126, v205
    v_mul_f32 v127, v127, v205
    v_sub_f32 v32, v32, v204
    v_sub_f32 v33, v33, v204
    v_sub_f32 v34, v34, v204
    v_sub_f32 v35, v35, v204
    v_sub_f32 v36, v36, v204
    v_sub_f32 v37, v37, v204
    v_sub_f32 v38, v38, v204
    v_sub_f32 v39, v39, v204
    v_sub_f32 v40, v40, v204
    v_sub_f32 v41, v41, v204
    v_sub_f32 v42, v42, v204
    v_sub_f32 v43, v43, v204
    v_sub_f32 v44, v44, v204
    v_sub_f32 v45, v45, v204
    v_sub_f32 v46, v46, v204
    v_sub_f32 v47, v47, v204
    v_sub_f32 v48, v48, v204
    v_sub_f32 v49, v49, v204
    v_sub_f32 v50, v50, v204
    v_sub_f32 v51, v51, v204
    v_sub_f32 v52, v52, v204
    v_sub_f32 v53, v53, v204
    v_sub_f32 v54, v54, v204
    v_sub_f32 v55, v55, v204
    v_sub_f32 v56, v56, v204
    v_sub_f32 v57, v57, v204
    v_sub_f32 v58, v58, v204
    v_sub_f32 v59, v59, v204
    v_sub_f32 v60, v60, v204
    v_sub_f32 v61, v61, v204
    v_sub_f32 v62, v62, v204
    v_sub_f32 v63, v63, v204
    v_exp_f32 v64, v32
    v_exp_f32 v65, v33
    v_exp_f32 v66, v34
    v_exp_f32 v67, v35
    v_exp_f32 v68, v36
    v_exp_f32 v69, v37
    v_exp_f32 v70, v38
    v_exp_f32 v71, v39
    v_exp_f32 v72, v40
    v_exp_f32 v73, v41
    v_exp_f32 v74, v42
    v_exp_f32 v75, v43
    v_exp_f32 v76, v44
    v_exp_f32 v77, v45
    v_exp_f32 v78, v46
    v_exp_f32 v79, v47
    v_cvt_pk_bf16_f32 v80, v64, v65
    v_cvt_pk_bf16_f32 v81, v66, v67
    v_cvt_pk_bf16_f32 v82, v68, v69
    v_cvt_pk_bf16_f32 v83, v70, v71
    v_cvt_pk_bf16_f32 v84, v72, v73
    v_cvt_pk_bf16_f32 v85, v74, v75
    v_cvt_pk_bf16_f32 v86, v76, v77
    v_cvt_pk_bf16_f32 v87, v78, v79
    s_nop 1
    s_branch BACK_A0
RARE_A1:
    v_max3_f32 v204, v48, v49, v50
    v_max3_f32 v205, v51, v52, v53
    v_max3_f32 v204, v204, v54, v55
    v_max3_f32 v205, v205, v56, v57
    v_max3_f32 v204, v204, v58, v59
    v_max3_f32 v205, v205, v60, v61
    v_max3_f32 v204, v204, v62, v63
    v_max_f32 v204, v204, v205
    v_mov_b32 v205, v204
    s_nop 1
    v_permlane32_swap_b32 v204, v205
    v_max_f32 v204, v204, v205
    v_add_f32 v204, 0x42a00000, v204
    v_max_f32 v204, 0, v204
    v_max_f32 v205, 0, v204
    v_sub_f32 v205, 0, v205
    v_exp_f32 v205, v205
    v_sub_f32 v203, v203, v204
    v_mov_b32 v96, v203
    v_mov_b32 v97, v203
    v_mov_b32 v98, v203
    v_mov_b32 v99, v203
    v_mov_b32 v100, v203
    v_mov_b32 v101, v203
    v_mov_b32 v102, v203
    v_mov_b32 v103, v203
    v_mov_b32 v104, v203
    v_mov_b32 v105, v203
    v_mov_b32 v106, v203
    v_mov_b32 v107, v203
    v_mov_b32 v108, v203
    v_mov_b32 v109, v203
    v_mov_b32 v110, v203
    v_mov_b32 v111, v203
    v_mul_f32 v112, v112, v205
    v_mul_f32 v113, v113, v205
    v_mul_f32 v114, v114, v205
    v_mul_f32 v115, v115, v205
    v_mul_f32 v116, v116, v205
    v_mul_f32 v117, v117, v205
    v_mul_f32 v118, v118, v205
    v_mul_f32 v119, v119, v205
    v_mul_f32 v120, v120, v205
    v_mul_f32 v121, v121, v205
    v_mul_f32 v122, v122, v205
    v_mul_f32 v123, v123, v205
    v_mul_f32 v124, v124, v205
    v_mul_f32 v125, v125, v205
    v_mul_f32 v126, v126, v205
    v_mul_f32 v127, v127, v205
    v_sub_f32 v48, v48, v204
    v_sub_f32 v49, v49, v204
    v_sub_f32 v50, v50, v204
    v_sub_f32 v51, v51, v204
    v_sub_f32 v52, v52, v204
    v_sub_f32 v53, v53, v204
    v_sub_f32 v54, v54, v204
    v_sub_f32 v55, v55, v204
    v_sub_f32 v56, v56, v204
    v_sub_f32 v57, v57, v204
    v_sub_f32 v58, v58, v204
    v_sub_f32 v59, v59, v204
    v_sub_f32 v60, v60, v204
    v_sub_f32 v61, v61, v204
    v_sub_f32 v62, v62, v204
    v_sub_f32 v63, v63, v204
    v_sub_f32 v32, v32, v204
    v_sub_f32 v33, v33, v204
    v_sub_f32 v34, v34, v204
    v_sub_f32 v35, v35, v204
    v_sub_f32 v36, v36, v204
    v_sub_f32 v37, v37, v204
    v_sub_f32 v38, v38, v204
    v_sub_f32 v39, v39, v204
    v_sub_f32 v40, v40, v204
    v_sub_f32 v41, v41, v204
    v_sub_f32 v42, v42, v204
    v_sub_f32 v43, v43, v204
    v_sub_f32 v44, v44, v204
    v_sub_f32 v45, v45, v204
    v_sub_f32 v46, v46, v204
    v_sub_f32 v47, v47, v204
    v_exp_f32 v64, v48
    v_exp_f32 v65, v49
    v_exp_f32 v66, v50
    v_exp_f32 v67, v51
    v_exp_f32 v68, v52
    v_exp_f32 v69, v53
    v_exp_f32 v70, v54
    v_exp_f32 v71, v55
    v_exp_f32 v72, v56
    v_exp_f32 v73, v57
    v_exp_f32 v74, v58
    v_exp_f32 v75, v59
    v_exp_f32 v76, v60
    v_exp_f32 v77, v61
    v_exp_f32 v78, v62
    v_exp_f32 v79, v63
    v_cvt_pk_bf16_f32 v80, v64, v65
    v_cvt_pk_bf16_f32 v81, v66, v67
    v_cvt_pk_bf16_f32 v82, v68, v69
    v_cvt_pk_bf16_f32 v83, v70, v71
    v_cvt_pk_bf16_f32 v84, v72, v73
    v_cvt_pk_bf16_f32 v85, v74, v75
    v_cvt_pk_bf16_f32 v86, v76, v77
    v_cvt_pk_bf16_f32 v87, v78, v79
    s_nop 1
    s_branch BACK_A1
.globl oproj_kernel
.p2align 8
.type oproj_kernel,@function
oproj_kernel:
    s_cmp_ge_u32 s2, 256
    s_cbranch_scc1 K3_END
    s_load_dwordx2 s[4:5], s[0:1], 16
    s_load_dwordx2 s[6:7], s[0:1], 40
    s_load_dwordx2 s[8:9], s[0:1], 56
    s_load_dwordx2 s[26:27], s[0:1], 72
    v_and_b32 v1, 63, v0
    v_lshrrev_b32 v2, 6, v0
    s_nop 0
    v_readfirstlane_b32 s28, v2
    s_and_b32 s30, s2, 7
    s_lshr_b32 s29, s2, 3
    s_lshr_b32 s33, s29, 3
    s_and_b32 s29, s29, 7
    s_lshl_b32 s33, s33, 3
    s_add_u32 s30, s30, s33
    s_waitcnt lgkmcnt(0)
    s_mov_b32 s20, s26
    s_and_b32 s21, s27, 0xffff
    s_mov_b32 s22, 0x1800000
    s_mov_b32 s23, 0x00020000
    s_mov_b32 s12, s4
    s_and_b32 s13, s5, 0xffff
    s_mov_b32 s14, 0xc8000
    s_mov_b32 s15, 0x00020000
    s_mov_b32 s16, s6
    s_and_b32 s17, s7, 0xffff
    s_mov_b32 s18, 0xc8000
    s_mov_b32 s19, 0x00020000
    s_mov_b32 s24, s8
    s_and_b32 s25, s9, 0xffff
    s_mov_b32 s26, 0x280000
    s_mov_b32 s27, 0x00020000
    v_lshrrev_b32 v3, 3, v1
    v_and_b32 v4, 7, v1
    v_lshrrev_b32 v5, 4, v1
    s_and_b32 s33, s28, 1
    s_lshl_b32 s33, s33, 2
    v_xor_b32 v5, s33, v5
    v_xor_b32 v4, v4, v5
    s_lshl_b32 s33, s30, 6
    s_lshl_b32 s34, s28, 3
    s_add_u32 s33, s33, s34
    v_add_u32 v6, s33, v3
    v_mul_u32_u24 v6, 2560, v6
    v_lshl_add_u32 v6, v4, 4, v6
    v_add_u32 v120, 0x1300000, v6
    s_add_u32 s33, s28, 0
    s_cmp_ge_u32 s33, 10
    s_cselect_b32 s34, 1, 0
    s_mul_i32 s35, s34, 10
    s_sub_u32 s35, s33, s35
    s_lshl_b32 s36, s35, 6
    v_add_u32 v5, s36, v1
    v_mul_u32_u24 v6, 6554, v5
    v_lshrrev_b32 v6, 16, v6
    v_mul_u32_u24 v7, 10, v6
    v_sub_u32 v7, v5, v7
    v_mul_u32_u24 v8, 1280, v6
    v_lshl_add_u32 v8, v7, 4, v8
    s_mul_i32 s37, s29, 160
    v_add_u32 v121, s37, v8
    s_mul_i32 s37, s34, 10240
    s_lshl_b32 s36, s35, 10
    s_add_u32 s37, s37, s36
    s_add_u32 s50, s37, 16384
    s_mov_b32 s54, s34
    s_add_u32 s33, s28, 8
    s_cmp_ge_u32 s33, 10
    s_cselect_b32 s34, 1, 0
    s_mul_i32 s35, s34, 10
    s_sub_u32 s35, s33, s35
    s_lshl_b32 s36, s35, 6
    v_add_u32 v5, s36, v1
    v_mul_u32_u24 v6, 6554, v5
    v_lshrrev_b32 v6, 16, v6
    v_mul_u32_u24 v7, 10, v6
    v_sub_u32 v7, v5, v7
    v_mul_u32_u24 v8, 1280, v6
    v_lshl_add_u32 v8, v7, 4, v8
    s_mul_i32 s37, s29, 160
    v_add_u32 v122, s37, v8
    s_mul_i32 s37, s34, 10240
    s_lshl_b32 s36, s35, 10
    s_add_u32 s37, s37, s36
    s_add_u32 s51, s37, 16384
    s_mov_b32 s55, s34
    s_add_u32 s33, s28, 16
    s_cmp_ge_u32 s33, 10
    s_cselect_b32 s34, 1, 0
    s_mul_i32 s35, s34, 10
    s_sub_u32 s35, s33, s35
    s_lshl_b32 s36, s35, 6
    v_add_u32 v5, s36, v1
    v_mul_u32_u24 v6, 6554, v5
    v_lshrrev_b32 v6, 16, v6
    v_mul_u32_u24 v7, 10, v6
    v_sub_u32 v7, v5, v7
    v_mul_u32_u24 v8, 1280, v6
    v_lshl_add_u32 v8, v7, 4, v8
    s_mul_i32 s37, s29, 160
    v_add_u32 v123, s37, v8
    s_mul_i32 s37, s34, 10240
    s_lshl_b32 s36, s35, 10
    s_add_u32 s37, s37, s36
    s_add_u32 s52, s37, 16384
    s_mov_b32 s56, s34
    s_cmp_ge_u32 s33, 20
    s_cbranch_scc0 K3_N2OK
    v_mov_b32 v123, 0x7ffffff0
    s_mov_b32 s52, 36864
    s_mov_b32 s56, 0
K3_N2OK:
    s_cmp_eq_u32 s54, 1
    s_cselect_b32 s60, s16, s12
    s_cselect_b32 s61, s17, s13
    s_cselect_b32 s62, s18, s14
    s_cselect_b32 s63, s19, s15
    s_cmp_eq_u32 s55, 1
    s_cselect_b32 s64, s16, s12
    s_cselect_b32 s65, s17, s13
    s_cselect_b32 s66, s18, s14
    s_cselect_b32 s67, s19, s15
    s_cmp_eq_u32 s56, 1
    s_cselect_b32 s68, s16, s12
    s_cselect_b32 s69, s17, s13
    s_cselect_b32 s70, s18, s14
    s_cselect_b32 s71, s19, s15
    s_lshl_b32 s58, s28, 10
    s_lshr_b32 s34, s28, 2
    s_and_b32 s35, s28, 3
    v_and_b32 v3, 15, v1
    v_lshrrev_b32 v4, 4, v1
    s_lshl_b32 s33, s35, 4
    v_add_u32 v5, s33, v3
    v_bfe_u32 v6, v5, 1, 3
    v_lshlrev_b32 v7, 7, v5
    s_mul_i32 s33, s34, 8192
    v_add_u32 v7, s33, v7
    v_and_b32 v8, 1, v4
    v_lshl_add_u32 v7, v8, 3, v7
    v_lshrrev_b32 v8, 1, v4
    v_add_u32 v9, 0, v8
    v_xor_b32 v9, v9, v6
    v_lshl_add_u32 v124, v9, 4, v7
    v_add_u32 v9, 2, v8
    v_xor_b32 v9, v9, v6
    v_lshl_add_u32 v125, v9, 4, v7
    v_add_u32 v9, 4, v8
    v_xor_b32 v9, v9, v6
    v_lshl_add_u32 v126, v9, 4, v7
    v_add_u32 v9, 6, v8
    v_xor_b32 v9, v9, v6
    v_lshl_add_u32 v127, v9, 4, v7
    v_bfe_u32 v6, v1, 2, 2
    v_and_b32 v7, 3, v1
    v_lshl_add_u32 v8, v4, 2, v6
    v_mul_u32_u24 v8, 160, v8
    v_lshl_add_u32 v8, v7, 3, v8
    s_mul_i32 s33, s34, 10240
    s_add_u32 s33, s33, 16384
    v_add_u32 v128, s33, v8
    v_add_u32 v132, 37888, v124
    v_add_u32 v133, 37888, v125
    v_add_u32 v134, 37888, v126
    v_add_u32 v135, 37888, v127
    v_add_u32 v136, 37888, v128
    v_add_u32 v140, 75776, v124
    v_add_u32 v141, 75776, v125
    v_add_u32 v142, 75776, v126
    v_add_u32 v143, 75776, v127
    v_add_u32 v144, 75776, v128
    v_add_u32 v148, 113664, v124
    v_add_u32 v149, 113664, v125
    v_add_u32 v150, 113664, v126
    v_add_u32 v151, 113664, v127
    v_add_u32 v152, 113664, v128
    v_mov_b32 v32, 0
    v_mov_b32 v33, 0
    v_mov_b32 v34, 0
    v_mov_b32 v35, 0
    v_mov_b32 v36, 0
    v_mov_b32 v37, 0
    v_mov_b32 v38, 0
    v_mov_b32 v39, 0
    v_mov_b32 v40, 0
    v_mov_b32 v41, 0
    v_mov_b32 v42, 0
    v_mov_b32 v43, 0
    v_mov_b32 v44, 0
    v_mov_b32 v45, 0
    v_mov_b32 v46, 0
    v_mov_b32 v47, 0
    v_mov_b32 v48, 0
    v_mov_b32 v49, 0
    v_mov_b32 v50, 0
    v_mov_b32 v51, 0
    s_add_u32 m0, s58, 0
    s_movk_i32 s37, 0
    buffer_load_dwordx4 v120, s[20:23], s37 offen lds
    s_add_u32 m0, s58, 8192
    s_movk_i32 s37, 1280
    buffer_load_dwordx4 v120, s[20:23], s37 offen lds
    s_add_u32 m0, s50, 0
    s_mov_b32 s37, 0
    buffer_load_dwordx4 v121, s[60:63], s37 offen lds
    s_add_u32 m0, s51, 0
    s_mov_b32 s37, 0
    buffer_load_dwordx4 v122, s[64:67], s37 offen lds
    s_add_u32 m0, s52, 0
    s_mov_b32 s37, 0
    buffer_load_dwordx4 v123, s[68:71], s37 offen lds
    s_add_u32 m0, s58, 37888
    s_movk_i32 s37, 128
    buffer_load_dwordx4 v120, s[20:23], s37 offen lds
    s_add_u32 m0, s58, 46080
    s_movk_i32 s37, 1408
    buffer_load_dwordx4 v120, s[20:23], s37 offen lds
    s_add_u32 m0, s50, 37888
    s_mov_b32 s37, 81920
    buffer_load_dwordx4 v121, s[60:63], s37 offen lds
    s_add_u32 m0, s51, 37888
    s_mov_b32 s37, 81920
    buffer_load_dwordx4 v122, s[64:67], s37 offen lds
    s_add_u32 m0, s52, 37888
    s_mov_b32 s37, 81920
    buffer_load_dwordx4 v123, s[68:71], s37 offen lds
    s_add_u32 m0, s58, 75776
    s_movk_i32 s37, 256
    buffer_load_dwordx4 v120, s[20:23], s37 offen lds
    s_add_u32 m0, s58, 83968
    s_movk_i32 s37, 1536
    buffer_load_dwordx4 v120, s[20:23], s37 offen lds
    s_add_u32 m0, s50, 75776
    s_mov_b32 s37, 163840
    buffer_load_dwordx4 v121, s[60:63], s37 offen lds
    s_add_u32 m0, s51, 75776
    s_mov_b32 s37, 163840
    buffer_load_dwordx4 v122, s[64:67], s37 offen lds
    s_add_u32 m0, s52, 75776
    s_mov_b32 s37, 163840
    buffer_load_dwordx4 v123, s[68:71], s37 offen lds
    s_waitcnt vmcnt(10)
    s_barrier
    ds_read_b64 v[8:9], v124
    ds_read_b64 v[10:11], v125
    ds_read_b64_tr_b16 v[12:13], v128 offset:0
    ds_read_b64_tr_b16 v[14:15], v128 offset:2560
    ds_read_b64_tr_b16 v[16:17], v128 offset:32
    ds_read_b64_tr_b16 v[18:19], v128 offset:2592
    ds_read_b64_tr_b16 v[20:21], v128 offset:64
    ds_read_b64_tr_b16 v[22:23], v128 offset:2624
    ds_read_b64_tr_b16 v[24:25], v128 offset:96
    ds_read_b64_tr_b16 v[26:27], v128 offset:2656
    ds_read_b64_tr_b16 v[28:29], v128 offset:128
    ds_read_b64_tr_b16 v[30:31], v128 offset:2688
    ds_read_b64 v[88:89], v126
    ds_read_b64 v[90:91], v127
    ds_read_b64_tr_b16 v[92:93], v128 offset:5120
    ds_read_b64_tr_b16 v[94:95], v128 offset:7680
    ds_read_b64_tr_b16 v[96:97], v128 offset:5152
    ds_read_b64_tr_b16 v[98:99], v128 offset:7712
    ds_read_b64_tr_b16 v[100:101], v128 offset:5184
    ds_read_b64_tr_b16 v[102:103], v128 offset:7744
    ds_read_b64_tr_b16 v[104:105], v128 offset:5216
    ds_read_b64_tr_b16 v[106:107], v128 offset:7776
    ds_read_b64_tr_b16 v[108:109], v128 offset:5248
    ds_read_b64_tr_b16 v[110:111], v128 offset:7808
    s_add_u32 m0, s58, 113664
    s_movk_i32 s37, 384
    buffer_load_dwordx4 v120, s[20:23], s37 offen lds
    s_add_u32 m0, s58, 121856
    s_movk_i32 s37, 1664
    buffer_load_dwordx4 v120, s[20:23], s37 offen lds
    s_add_u32 m0, s50, 113664
    s_mov_b32 s37, 245760
    buffer_load_dwordx4 v121, s[60:63], s37 offen lds
    s_add_u32 m0, s51, 113664
    s_mov_b32 s37, 245760
    buffer_load_dwordx4 v122, s[64:67], s37 offen lds
    s_add_u32 m0, s52, 113664
    s_mov_b32 s37, 245760
    buffer_load_dwordx4 v123, s[68:71], s37 offen lds
    s_waitcnt lgkmcnt(12)
    v_mfma_f32_16x16x32_bf16 v[32:35], v[12:15], v[8:11], v[32:35]
    v_mfma_f32_16x16x32_bf16 v[36:39], v[16:19], v[8:11], v[36:39]
    v_mfma_f32_16x16x32_bf16 v[40:43], v[20:23], v[8:11], v[40:43]
    v_mfma_f32_16x16x32_bf16 v[44:47], v[24:27], v[8:11], v[44:47]
    v_mfma_f32_16x16x32_bf16 v[48:51], v[28:31], v[8:11], v[48:51]
    s_waitcnt lgkmcnt(0)
    v_mfma_f32_16x16x32_bf16 v[32:35], v[92:95], v[88:91], v[32:35]
    v_mfma_f32_16x16x32_bf16 v[36:39], v[96:99], v[88:91], v[36:39]
    v_mfma_f32_16x16x32_bf16 v[40:43], v[100:103], v[88:91], v[40:43]
    v_mfma_f32_16x16x32_bf16 v[44:47], v[104:107], v[88:91], v[44:47]
    v_mfma_f32_16x16x32_bf16 v[48:51], v[108:111], v[88:91], v[48:51]
    s_waitcnt vmcnt(10)
    s_barrier
    ds_read_b64 v[8:9], v132
    ds_read_b64 v[10:11], v133
    ds_read_b64_tr_b16 v[12:13], v136 offset:0
    ds_read_b64_tr_b16 v[14:15], v136 offset:2560
    ds_read_b64_tr_b16 v[16:17], v136 offset:32
    ds_read_b64_tr_b16 v[18:19], v136 offset:2592
    ds_read_b64_tr_b16 v[20:21], v136 offset:64
    ds_read_b64_tr_b16 v[22:23], v136 offset:2624
    ds_read_b64_tr_b16 v[24:25], v136 offset:96
    ds_read_b64_tr_b16 v[26:27], v136 offset:2656
    ds_read_b64_tr_b16 v[28:29], v136 offset:128
    ds_read_b64_tr_b16 v[30:31], v136 offset:2688
    ds_read_b64 v[88:89], v134
    ds_read_b64 v[90:91], v135
    ds_read_b64_tr_b16 v[92:93], v136 offset:5120
    ds_read_b64_tr_b16 v[94:95], v136 offset:7680
    ds_read_b64_tr_b16 v[96:97], v136 offset:5152
    ds_read_b64_tr_b16 v[98:99], v136 offset:7712
    ds_read_b64_tr_b16 v[100:101], v136 offset:5184
    ds_read_b64_tr_b16 v[102:103], v136 offset:7744
    ds_read_b64_tr_b16 v[104:105], v136 offset:5216
    ds_read_b64_tr_b16 v[106:107], v136 offset:7776
    ds_read_b64_tr_b16 v[108:109], v136 offset:5248
    ds_read_b64_tr_b16 v[110:111], v136 offset:7808
    s_add_u32 m0, s58, 0
    s_movk_i32 s37, 512
    buffer_load_dwordx4 v120, s[20:23], s37 offen lds
    s_add_u32 m0, s58, 8192
    s_movk_i32 s37, 1792
    buffer_load_dwordx4 v120, s[20:23], s37 offen lds
    s_add_u32 m0, s50, 0
    s_mov_b32 s37, 327680
    buffer_load_dwordx4 v121, s[60:63], s37 offen lds
    s_add_u32 m0, s51, 0
    s_mov_b32 s37, 327680
    buffer_load_dwordx4 v122, s[64:67], s37 offen lds
    s_add_u32 m0, s52, 0
    s_mov_b32 s37, 327680
    buffer_load_dwordx4 v123, s[68:71], s37 offen lds
    s_waitcnt lgkmcnt(12)
    v_mfma_f32_16x16x32_bf16 v[32:35], v[12:15], v[8:11], v[32:35]
    v_mfma_f32_16x16x32_bf16 v[36:39], v[16:19], v[8:11], v[36:39]
    v_mfma_f32_16x16x32_bf16 v[40:43], v[20:23], v[8:11], v[40:43]
    v_mfma_f32_16x16x32_bf16 v[44:47], v[24:27], v[8:11], v[44:47]
    v_mfma_f32_16x16x32_bf16 v[48:51], v[28:31], v[8:11], v[48:51]
    s_waitcnt lgkmcnt(0)
    v_mfma_f32_16x16x32_bf16 v[32:35], v[92:95], v[88:91], v[32:35]
    v_mfma_f32_16x16x32_bf16 v[36:39], v[96:99], v[88:91], v[36:39]
    v_mfma_f32_16x16x32_bf16 v[40:43], v[100:103], v[88:91], v[40:43]
    v_mfma_f32_16x16x32_bf16 v[44:47], v[104:107], v[88:91], v[44:47]
    v_mfma_f32_16x16x32_bf16 v[48:51], v[108:111], v[88:91], v[48:51]
    s_waitcnt vmcnt(10)
    s_barrier
    ds_read_b64 v[8:9], v140
    ds_read_b64 v[10:11], v141
    ds_read_b64_tr_b16 v[12:13], v144 offset:0
    ds_read_b64_tr_b16 v[14:15], v144 offset:2560
    ds_read_b64_tr_b16 v[16:17], v144 offset:32
    ds_read_b64_tr_b16 v[18:19], v144 offset:2592
    ds_read_b64_tr_b16 v[20:21], v144 offset:64
    ds_read_b64_tr_b16 v[22:23], v144 offset:2624
    ds_read_b64_tr_b16 v[24:25], v144 offset:96
    ds_read_b64_tr_b16 v[26:27], v144 offset:2656
    ds_read_b64_tr_b16 v[28:29], v144 offset:128
    ds_read_b64_tr_b16 v[30:31], v144 offset:2688
    ds_read_b64 v[88:89], v142
    ds_read_b64 v[90:91], v143
    ds_read_b64_tr_b16 v[92:93], v144 offset:5120
    ds_read_b64_tr_b16 v[94:95], v144 offset:7680
    ds_read_b64_tr_b16 v[96:97], v144 offset:5152
    ds_read_b64_tr_b16 v[98:99], v144 offset:7712
    ds_read_b64_tr_b16 v[100:101], v144 offset:5184
    ds_read_b64_tr_b16 v[102:103], v144 offset:7744
    ds_read_b64_tr_b16 v[104:105], v144 offset:5216
    ds_read_b64_tr_b16 v[106:107], v144 offset:7776
    ds_read_b64_tr_b16 v[108:109], v144 offset:5248
    ds_read_b64_tr_b16 v[110:111], v144 offset:7808
    s_add_u32 m0, s58, 37888
    s_movk_i32 s37, 640
    buffer_load_dwordx4 v120, s[20:23], s37 offen lds
    s_add_u32 m0, s58, 46080
    s_movk_i32 s37, 1920
    buffer_load_dwordx4 v120, s[20:23], s37 offen lds
    s_add_u32 m0, s50, 37888
    s_mov_b32 s37, 409600
    buffer_load_dwordx4 v121, s[60:63], s37 offen lds
    s_add_u32 m0, s51, 37888
    s_mov_b32 s37, 409600
    buffer_load_dwordx4 v122, s[64:67], s37 offen lds
    s_add_u32 m0, s52, 37888
    s_mov_b32 s37, 409600
    buffer_load_dwordx4 v123, s[68:71], s37 offen lds
    s_waitcnt lgkmcnt(12)
    v_mfma_f32_16x16x32_bf16 v[32:35], v[12:15], v[8:11], v[32:35]
    v_mfma_f32_16x16x32_bf16 v[36:39], v[16:19], v[8:11], v[36:39]
    v_mfma_f32_16x16x32_bf16 v[40:43], v[20:23], v[8:11], v[40:43]
    v_mfma_f32_16x16x32_bf16 v[44:47], v[24:27], v[8:11], v[44:47]
    v_mfma_f32_16x16x32_bf16 v[48:51], v[28:31], v[8:11], v[48:51]
    s_waitcnt lgkmcnt(0)
    v_mfma_f32_16x16x32_bf16 v[32:35], v[92:95], v[88:91], v[32:35]
    v_mfma_f32_16x16x32_bf16 v[36:39], v[96:99], v[88:91], v[36:39]
    v_mfma_f32_16x16x32_bf16 v[40:43], v[100:103], v[88:91], v[40:43]
    v_mfma_f32_16x16x32_bf16 v[44:47], v[104:107], v[88:91], v[44:47]
    v_mfma_f32_16x16x32_bf16 v[48:51], v[108:111], v[88:91], v[48:51]
    s_waitcnt vmcnt(10)
    s_barrier
    ds_read_b64 v[8:9], v148
    ds_read_b64 v[10:11], v149
    ds_read_b64_tr_b16 v[12:13], v152 offset:0
    ds_read_b64_tr_b16 v[14:15], v152 offset:2560
    ds_read_b64_tr_b16 v[16:17], v152 offset:32
    ds_read_b64_tr_b16 v[18:19], v152 offset:2592
    ds_read_b64_tr_b16 v[20:21], v152 offset:64
    ds_read_b64_tr_b16 v[22:23], v152 offset:2624
    ds_read_b64_tr_b16 v[24:25], v152 offset:96
    ds_read_b64_tr_b16 v[26:27], v152 offset:2656
    ds_read_b64_tr_b16 v[28:29], v152 offset:128
    ds_read_b64_tr_b16 v[30:31], v152 offset:2688
    ds_read_b64 v[88:89], v150
    ds_read_b64 v[90:91], v151
    ds_read_b64_tr_b16 v[92:93], v152 offset:5120
    ds_read_b64_tr_b16 v[94:95], v152 offset:7680
    ds_read_b64_tr_b16 v[96:97], v152 offset:5152
    ds_read_b64_tr_b16 v[98:99], v152 offset:7712
    ds_read_b64_tr_b16 v[100:101], v152 offset:5184
    ds_read_b64_tr_b16 v[102:103], v152 offset:7744
    ds_read_b64_tr_b16 v[104:105], v152 offset:5216
    ds_read_b64_tr_b16 v[106:107], v152 offset:7776
    ds_read_b64_tr_b16 v[108:109], v152 offset:5248
    ds_read_b64_tr_b16 v[110:111], v152 offset:7808
    s_add_u32 m0, s58, 75776
    s_movk_i32 s37, 768
    buffer_load_dwordx4 v120, s[20:23], s37 offen lds
    s_add_u32 m0, s58, 83968
    s_movk_i32 s37, 2048
    buffer_load_dwordx4 v120, s[20:23], s37 offen lds
    s_add_u32 m0, s50, 75776
    s_mov_b32 s37, 491520
    buffer_load_dwordx4 v121, s[60:63], s37 offen lds
    s_add_u32 m0, s51, 75776
    s_mov_b32 s37, 491520
    buffer_load_dwordx4 v122, s[64:67], s37 offen lds
    s_add_u32 m0, s52, 75776
    s_mov_b32 s37, 491520
    buffer_load_dwordx4 v123, s[68:71], s37 offen lds
    s_waitcnt lgkmcnt(12)
    v_mfma_f32_16x16x32_bf16 v[32:35], v[12:15], v[8:11], v[32:35]
    v_mfma_f32_16x16x32_bf16 v[36:39], v[16:19], v[8:11], v[36:39]
    v_mfma_f32_16x16x32_bf16 v[40:43], v[20:23], v[8:11], v[40:43]
    v_mfma_f32_16x16x32_bf16 v[44:47], v[24:27], v[8:11], v[44:47]
    v_mfma_f32_16x16x32_bf16 v[48:51], v[28:31], v[8:11], v[48:51]
    s_waitcnt lgkmcnt(0)
    v_mfma_f32_16x16x32_bf16 v[32:35], v[92:95], v[88:91], v[32:35]
    v_mfma_f32_16x16x32_bf16 v[36:39], v[96:99], v[88:91], v[36:39]
    v_mfma_f32_16x16x32_bf16 v[40:43], v[100:103], v[88:91], v[40:43]
    v_mfma_f32_16x16x32_bf16 v[44:47], v[104:107], v[88:91], v[44:47]
    v_mfma_f32_16x16x32_bf16 v[48:51], v[108:111], v[88:91], v[48:51]
    s_waitcnt vmcnt(10)
    s_barrier
    ds_read_b64 v[8:9], v124
    ds_read_b64 v[10:11], v125
    ds_read_b64_tr_b16 v[12:13], v128 offset:0
    ds_read_b64_tr_b16 v[14:15], v128 offset:2560
    ds_read_b64_tr_b16 v[16:17], v128 offset:32
    ds_read_b64_tr_b16 v[18:19], v128 offset:2592
    ds_read_b64_tr_b16 v[20:21], v128 offset:64
    ds_read_b64_tr_b16 v[22:23], v128 offset:2624
    ds_read_b64_tr_b16 v[24:25], v128 offset:96
    ds_read_b64_tr_b16 v[26:27], v128 offset:2656
    ds_read_b64_tr_b16 v[28:29], v128 offset:128
    ds_read_b64_tr_b16 v[30:31], v128 offset:2688
    ds_read_b64 v[88:89], v126
    ds_read_b64 v[90:91], v127
    ds_read_b64_tr_b16 v[92:93], v128 offset:5120
    ds_read_b64_tr_b16 v[94:95], v128 offset:7680
    ds_read_b64_tr_b16 v[96:97], v128 offset:5152
    ds_read_b64_tr_b16 v[98:99], v128 offset:7712
    ds_read_b64_tr_b16 v[100:101], v128 offset:5184
    ds_read_b64_tr_b16 v[102:103], v128 offset:7744
    ds_read_b64_tr_b16 v[104:105], v128 offset:5216
    ds_read_b64_tr_b16 v[106:107], v128 offset:7776
    ds_read_b64_tr_b16 v[108:109], v128 offset:5248
    ds_read_b64_tr_b16 v[110:111], v128 offset:7808
    s_add_u32 m0, s58, 113664
    s_movk_i32 s37, 896
    buffer_load_dwordx4 v120, s[20:23], s37 offen lds
    s_add_u32 m0, s58, 121856
    s_movk_i32 s37, 2176
    buffer_load_dwordx4 v120, s[20:23], s37 offen lds
    s_add_u32 m0, s50, 113664
    s_mov_b32 s37, 573440
    buffer_load_dwordx4 v121, s[60:63], s37 offen lds
    s_add_u32 m0, s51, 113664
    s_mov_b32 s37, 573440
    buffer_load_dwordx4 v122, s[64:67], s37 offen lds
    s_add_u32 m0, s52, 113664
    s_mov_b32 s37, 573440
    buffer_load_dwordx4 v123, s[68:71], s37 offen lds
    s_waitcnt lgkmcnt(12)
    v_mfma_f32_16x16x32_bf16 v[32:35], v[12:15], v[8:11], v[32:35]
    v_mfma_f32_16x16x32_bf16 v[36:39], v[16:19], v[8:11], v[36:39]
    v_mfma_f32_16x16x32_bf16 v[40:43], v[20:23], v[8:11], v[40:43]
    v_mfma_f32_16x16x32_bf16 v[44:47], v[24:27], v[8:11], v[44:47]
    v_mfma_f32_16x16x32_bf16 v[48:51], v[28:31], v[8:11], v[48:51]
    s_waitcnt lgkmcnt(0)
    v_mfma_f32_16x16x32_bf16 v[32:35], v[92:95], v[88:91], v[32:35]
    v_mfma_f32_16x16x32_bf16 v[36:39], v[96:99], v[88:91], v[36:39]
    v_mfma_f32_16x16x32_bf16 v[40:43], v[100:103], v[88:91], v[40:43]
    v_mfma_f32_16x16x32_bf16 v[44:47], v[104:107], v[88:91], v[44:47]
    v_mfma_f32_16x16x32_bf16 v[48:51], v[108:111], v[88:91], v[48:51]
    s_waitcnt vmcnt(10)
    s_barrier
    ds_read_b64 v[8:9], v132
    ds_read_b64 v[10:11], v133
    ds_read_b64_tr_b16 v[12:13], v136 offset:0
    ds_read_b64_tr_b16 v[14:15], v136 offset:2560
    ds_read_b64_tr_b16 v[16:17], v136 offset:32
    ds_read_b64_tr_b16 v[18:19], v136 offset:2592
    ds_read_b64_tr_b16 v[20:21], v136 offset:64
    ds_read_b64_tr_b16 v[22:23], v136 offset:2624
    ds_read_b64_tr_b16 v[24:25], v136 offset:96
    ds_read_b64_tr_b16 v[26:27], v136 offset:2656
    ds_read_b64_tr_b16 v[28:29], v136 offset:128
    ds_read_b64_tr_b16 v[30:31], v136 offset:2688
    ds_read_b64 v[88:89], v134
    ds_read_b64 v[90:91], v135
    ds_read_b64_tr_b16 v[92:93], v136 offset:5120
    ds_read_b64_tr_b16 v[94:95], v136 offset:7680
    ds_read_b64_tr_b16 v[96:97], v136 offset:5152
    ds_read_b64_tr_b16 v[98:99], v136 offset:7712
    ds_read_b64_tr_b16 v[100:101], v136 offset:5184
    ds_read_b64_tr_b16 v[102:103], v136 offset:7744
    ds_read_b64_tr_b16 v[104:105], v136 offset:5216
    ds_read_b64_tr_b16 v[106:107], v136 offset:7776
    ds_read_b64_tr_b16 v[108:109], v136 offset:5248
    ds_read_b64_tr_b16 v[110:111], v136 offset:7808
    s_add_u32 m0, s58, 0
    s_movk_i32 s37, 1024
    buffer_load_dwordx4 v120, s[20:23], s37 offen lds
    s_add_u32 m0, s58, 8192
    s_movk_i32 s37, 2304
    buffer_load_dwordx4 v120, s[20:23], s37 offen lds
    s_add_u32 m0, s50, 0
    s_mov_b32 s37, 655360
    buffer_load_dwordx4 v121, s[60:63], s37 offen lds
    s_add_u32 m0, s51, 0
    s_mov_b32 s37, 655360
    buffer_load_dwordx4 v122, s[64:67], s37 offen lds
    s_add_u32 m0, s52, 0
    s_mov_b32 s37, 655360
    buffer_load_dwordx4 v123, s[68:71], s37 offen lds
    s_waitcnt lgkmcnt(12)
    v_mfma_f32_16x16x32_bf16 v[32:35], v[12:15], v[8:11], v[32:35]
    v_mfma_f32_16x16x32_bf16 v[36:39], v[16:19], v[8:11], v[36:39]
    v_mfma_f32_16x16x32_bf16 v[40:43], v[20:23], v[8:11], v[40:43]
    v_mfma_f32_16x16x32_bf16 v[44:47], v[24:27], v[8:11], v[44:47]
    v_mfma_f32_16x16x32_bf16 v[48:51], v[28:31], v[8:11], v[48:51]
    s_waitcnt lgkmcnt(0)
    v_mfma_f32_16x16x32_bf16 v[32:35], v[92:95], v[88:91], v[32:35]
    v_mfma_f32_16x16x32_bf16 v[36:39], v[96:99], v[88:91], v[36:39]
    v_mfma_f32_16x16x32_bf16 v[40:43], v[100:103], v[88:91], v[40:43]
    v_mfma_f32_16x16x32_bf16 v[44:47], v[104:107], v[88:91], v[44:47]
    v_mfma_f32_16x16x32_bf16 v[48:51], v[108:111], v[88:91], v[48:51]
    s_waitcnt vmcnt(10)
    s_barrier
    ds_read_b64 v[8:9], v140
    ds_read_b64 v[10:11], v141
    ds_read_b64_tr_b16 v[12:13], v144 offset:0
    ds_read_b64_tr_b16 v[14:15], v144 offset:2560
    ds_read_b64_tr_b16 v[16:17], v144 offset:32
    ds_read_b64_tr_b16 v[18:19], v144 offset:2592
    ds_read_b64_tr_b16 v[20:21], v144 offset:64
    ds_read_b64_tr_b16 v[22:23], v144 offset:2624
    ds_read_b64_tr_b16 v[24:25], v144 offset:96
    ds_read_b64_tr_b16 v[26:27], v144 offset:2656
    ds_read_b64_tr_b16 v[28:29], v144 offset:128
    ds_read_b64_tr_b16 v[30:31], v144 offset:2688
    ds_read_b64 v[88:89], v142
    ds_read_b64 v[90:91], v143
    ds_read_b64_tr_b16 v[92:93], v144 offset:5120
    ds_read_b64_tr_b16 v[94:95], v144 offset:7680
    ds_read_b64_tr_b16 v[96:97], v144 offset:5152
    ds_read_b64_tr_b16 v[98:99], v144 offset:7712
    ds_read_b64_tr_b16 v[100:101], v144 offset:5184
    ds_read_b64_tr_b16 v[102:103], v144 offset:7744
    ds_read_b64_tr_b16 v[104:105], v144 offset:5216
    ds_read_b64_tr_b16 v[106:107], v144 offset:7776
    ds_read_b64_tr_b16 v[108:109], v144 offset:5248
    ds_read_b64_tr_b16 v[110:111], v144 offset:7808
    s_add_u32 m0, s58, 37888
    s_movk_i32 s37, 1152
    buffer_load_dwordx4 v120, s[20:23], s37 offen lds
    s_add_u32 m0, s58, 46080
    s_movk_i32 s37, 2432
    buffer_load_dwordx4 v120, s[20:23], s37 offen lds
    s_add_u32 m0, s50, 37888
    s_mov_b32 s37, 737280
    buffer_load_dwordx4 v121, s[60:63], s37 offen lds
    s_add_u32 m0, s51, 37888
    s_mov_b32 s37, 737280
    buffer_load_dwordx4 v122, s[64:67], s37 offen lds
    s_add_u32 m0, s52, 37888
    s_mov_b32 s37, 737280
    buffer_load_dwordx4 v123, s[68:71], s37 offen lds
    s_waitcnt lgkmcnt(12)
    v_mfma_f32_16x16x32_bf16 v[32:35], v[12:15], v[8:11], v[32:35]
    v_mfma_f32_16x16x32_bf16 v[36:39], v[16:19], v[8:11], v[36:39]
    v_mfma_f32_16x16x32_bf16 v[40:43], v[20:23], v[8:11], v[40:43]
    v_mfma_f32_16x16x32_bf16 v[44:47], v[24:27], v[8:11], v[44:47]
    v_mfma_f32_16x16x32_bf16 v[48:51], v[28:31], v[8:11], v[48:51]
    s_waitcnt lgkmcnt(0)
    v_mfma_f32_16x16x32_bf16 v[32:35], v[92:95], v[88:91], v[32:35]
    v_mfma_f32_16x16x32_bf16 v[36:39], v[96:99], v[88:91], v[36:39]
    v_mfma_f32_16x16x32_bf16 v[40:43], v[100:103], v[88:91], v[40:43]
    v_mfma_f32_16x16x32_bf16 v[44:47], v[104:107], v[88:91], v[44:47]
    v_mfma_f32_16x16x32_bf16 v[48:51], v[108:111], v[88:91], v[48:51]
    s_waitcnt vmcnt(10)
    s_barrier
    ds_read_b64 v[8:9], v148
    ds_read_b64 v[10:11], v149
    ds_read_b64_tr_b16 v[12:13], v152 offset:0
    ds_read_b64_tr_b16 v[14:15], v152 offset:2560
    ds_read_b64_tr_b16 v[16:17], v152 offset:32
    ds_read_b64_tr_b16 v[18:19], v152 offset:2592
    ds_read_b64_tr_b16 v[20:21], v152 offset:64
    ds_read_b64_tr_b16 v[22:23], v152 offset:2624
    ds_read_b64_tr_b16 v[24:25], v152 offset:96
    ds_read_b64_tr_b16 v[26:27], v152 offset:2656
    ds_read_b64_tr_b16 v[28:29], v152 offset:128
    ds_read_b64_tr_b16 v[30:31], v152 offset:2688
    ds_read_b64 v[88:89], v150
    ds_read_b64 v[90:91], v151
    ds_read_b64_tr_b16 v[92:93], v152 offset:5120
    ds_read_b64_tr_b16 v[94:95], v152 offset:7680
    ds_read_b64_tr_b16 v[96:97], v152 offset:5152
    ds_read_b64_tr_b16 v[98:99], v152 offset:7712
    ds_read_b64_tr_b16 v[100:101], v152 offset:5184
    ds_read_b64_tr_b16 v[102:103], v152 offset:7744
    ds_read_b64_tr_b16 v[104:105], v152 offset:5216
    ds_read_b64_tr_b16 v[106:107], v152 offset:7776
    ds_read_b64_tr_b16 v[108:109], v152 offset:5248
    ds_read_b64_tr_b16 v[110:111], v152 offset:7808
    s_waitcnt lgkmcnt(12)
    v_mfma_f32_16x16x32_bf16 v[32:35], v[12:15], v[8:11], v[32:35]
    v_mfma_f32_16x16x32_bf16 v[36:39], v[16:19], v[8:11], v[36:39]
    v_mfma_f32_16x16x32_bf16 v[40:43], v[20:23], v[8:11], v[40:43]
    v_mfma_f32_16x16x32_bf16 v[44:47], v[24:27], v[8:11], v[44:47]
    v_mfma_f32_16x16x32_bf16 v[48:51], v[28:31], v[8:11], v[48:51]
    s_waitcnt lgkmcnt(0)
    v_mfma_f32_16x16x32_bf16 v[32:35], v[92:95], v[88:91], v[32:35]
    v_mfma_f32_16x16x32_bf16 v[36:39], v[96:99], v[88:91], v[36:39]
    v_mfma_f32_16x16x32_bf16 v[40:43], v[100:103], v[88:91], v[40:43]
    v_mfma_f32_16x16x32_bf16 v[44:47], v[104:107], v[88:91], v[44:47]
    v_mfma_f32_16x16x32_bf16 v[48:51], v[108:111], v[88:91], v[48:51]
    s_waitcnt vmcnt(5)
    s_barrier
    ds_read_b64 v[8:9], v124
    ds_read_b64 v[10:11], v125
    ds_read_b64_tr_b16 v[12:13], v128 offset:0
    ds_read_b64_tr_b16 v[14:15], v128 offset:2560
    ds_read_b64_tr_b16 v[16:17], v128 offset:32
    ds_read_b64_tr_b16 v[18:19], v128 offset:2592
    ds_read_b64_tr_b16 v[20:21], v128 offset:64
    ds_read_b64_tr_b16 v[22:23], v128 offset:2624
    ds_read_b64_tr_b16 v[24:25], v128 offset:96
    ds_read_b64_tr_b16 v[26:27], v128 offset:2656
    ds_read_b64_tr_b16 v[28:29], v128 offset:128
    ds_read_b64_tr_b16 v[30:31], v128 offset:2688
    ds_read_b64 v[88:89], v126
    ds_read_b64 v[90:91], v127
    ds_read_b64_tr_b16 v[92:93], v128 offset:5120
    ds_read_b64_tr_b16 v[94:95], v128 offset:7680
    ds_read_b64_tr_b16 v[96:97], v128 offset:5152
    ds_read_b64_tr_b16 v[98:99], v128 offset:7712
    ds_read_b64_tr_b16 v[100:101], v128 offset:5184
    ds_read_b64_tr_b16 v[102:103], v128 offset:7744
    ds_read_b64_tr_b16 v[104:105], v128 offset:5216
    ds_read_b64_tr_b16 v[106:107], v128 offset:7776
    ds_read_b64_tr_b16 v[108:109], v128 offset:5248
    ds_read_b64_tr_b16 v[110:111], v128 offset:7808
    s_waitcnt lgkmcnt(12)
    v_mfma_f32_16x16x32_bf16 v[32:35], v[12:15], v[8:11], v[32:35]
    v_mfma_f32_16x16x32_bf16 v[36:39], v[16:19], v[8:11], v[36:39]
    v_mfma_f32_16x16x32_bf16 v[40:43], v[20:23], v[8:11], v[40:43]
    v_mfma_f32_16x16x32_bf16 v[44:47], v[24:27], v[8:11], v[44:47]
    v_mfma_f32_16x16x32_bf16 v[48:51], v[28:31], v[8:11], v[48:51]
    s_waitcnt lgkmcnt(0)
    v_mfma_f32_16x16x32_bf16 v[32:35], v[92:95], v[88:91], v[32:35]
    v_mfma_f32_16x16x32_bf16 v[36:39], v[96:99], v[88:91], v[36:39]
    v_mfma_f32_16x16x32_bf16 v[40:43], v[100:103], v[88:91], v[40:43]
    v_mfma_f32_16x16x32_bf16 v[44:47], v[104:107], v[88:91], v[44:47]
    v_mfma_f32_16x16x32_bf16 v[48:51], v[108:111], v[88:91], v[48:51]
    s_waitcnt vmcnt(0)
    s_barrier
    ds_read_b64 v[8:9], v132
    ds_read_b64 v[10:11], v133
    ds_read_b64_tr_b16 v[12:13], v136 offset:0
    ds_read_b64_tr_b16 v[14:15], v136 offset:2560
    ds_read_b64_tr_b16 v[16:17], v136 offset:32
    ds_read_b64_tr_b16 v[18:19], v136 offset:2592
    ds_read_b64_tr_b16 v[20:21], v136 offset:64
    ds_read_b64_tr_b16 v[22:23], v136 offset:2624
    ds_read_b64_tr_b16 v[24:25], v136 offset:96
    ds_read_b64_tr_b16 v[26:27], v136 offset:2656
    ds_read_b64_tr_b16 v[28:29], v136 offset:128
    ds_read_b64_tr_b16 v[30:31], v136 offset:2688
    ds_read_b64 v[88:89], v134
    ds_read_b64 v[90:91], v135
    ds_read_b64_tr_b16 v[92:93], v136 offset:5120
    ds_read_b64_tr_b16 v[94:95], v136 offset:7680
    ds_read_b64_tr_b16 v[96:97], v136 offset:5152
    ds_read_b64_tr_b16 v[98:99], v136 offset:7712
    ds_read_b64_tr_b16 v[100:101], v136 offset:5184
    ds_read_b64_tr_b16 v[102:103], v136 offset:7744
    ds_read_b64_tr_b16 v[104:105], v136 offset:5216
    ds_read_b64_tr_b16 v[106:107], v136 offset:7776
    ds_read_b64_tr_b16 v[108:109], v136 offset:5248
    ds_read_b64_tr_b16 v[110:111], v136 offset:7808
    s_waitcnt lgkmcnt(12)
    v_mfma_f32_16x16x32_bf16 v[32:35], v[12:15], v[8:11], v[32:35]
    v_mfma_f32_16x16x32_bf16 v[36:39], v[16:19], v[8:11], v[36:39]
    v_mfma_f32_16x16x32_bf16 v[40:43], v[20:23], v[8:11], v[40:43]
    v_mfma_f32_16x16x32_bf16 v[44:47], v[24:27], v[8:11], v[44:47]
    v_mfma_f32_16x16x32_bf16 v[48:51], v[28:31], v[8:11], v[48:51]
    s_waitcnt lgkmcnt(0)
    v_mfma_f32_16x16x32_bf16 v[32:35], v[92:95], v[88:91], v[32:35]
    v_mfma_f32_16x16x32_bf16 v[36:39], v[96:99], v[88:91], v[36:39]
    v_mfma_f32_16x16x32_bf16 v[40:43], v[100:103], v[88:91], v[40:43]
    v_mfma_f32_16x16x32_bf16 v[44:47], v[104:107], v[88:91], v[44:47]
    v_mfma_f32_16x16x32_bf16 v[48:51], v[108:111], v[88:91], v[48:51]
    s_lshl_b32 s33, s30, 6
    s_lshl_b32 s37, s35, 4
    s_add_u32 s33, s33, s37
    v_add_u32 v5, s33, v3
    v_lshlrev_b32 v6, 2, v5
    v_add_u32 v6, 0x1200000, v6
    buffer_load_dword v7, v6, s[20:23], 0 offen
    s_barrier
    s_waitcnt vmcnt(0)
    s_nop 7
    s_mul_i32 s33, s35, 5120
    v_lshlrev_b32 v8, 4, v1
    v_add_u32 v8, s33, v8
    s_cmp_eq_u32 s34, 0
    s_cbranch_scc1 K3_RED
    v_sub_f32 v7, 1.0, v7
    v_mul_f32 v32, v32, v7
    v_mul_f32 v33, v33, v7
    v_mul_f32 v34, v34, v7
    v_mul_f32 v35, v35, v7
    v_mul_f32 v36, v36, v7
    v_mul_f32 v37, v37, v7
    v_mul_f32 v38, v38, v7
    v_mul_f32 v39, v39, v7
    v_mul_f32 v40, v40, v7
    v_mul_f32 v41, v41, v7
    v_mul_f32 v42, v42, v7
    v_mul_f32 v43, v43, v7
    v_mul_f32 v44, v44, v7
    v_mul_f32 v45, v45, v7
    v_mul_f32 v46, v46, v7
    v_mul_f32 v47, v47, v7
    v_mul_f32 v48, v48, v7
    v_mul_f32 v49, v49, v7
    v_mul_f32 v50, v50, v7
    v_mul_f32 v51, v51, v7
    ds_write_b128 v8, v[32:35] offset:0
    ds_write_b128 v8, v[36:39] offset:1024
    ds_write_b128 v8, v[40:43] offset:2048
    ds_write_b128 v8, v[44:47] offset:3072
    ds_write_b128 v8, v[48:51] offset:4096
    s_waitcnt lgkmcnt(0)
    s_barrier
    s_branch K3_END
K3_RED:
    s_barrier
    ds_read_b128 v[64:67], v8 offset:0
    ds_read_b128 v[68:71], v8 offset:1024
    ds_read_b128 v[72:75], v8 offset:2048
    ds_read_b128 v[76:79], v8 offset:3072
    ds_read_b128 v[80:83], v8 offset:4096
    v_mul_u32_u24 v9, 1280, v5
    s_mul_i32 s33, s29, 160
    v_add_u32 v9, s33, v9
    v_lshl_add_u32 v9, v4, 3, v9
    s_waitcnt lgkmcnt(0)
    v_fma_f32 v32, v32, v7, v64
    v_fma_f32 v33, v33, v7, v65
    v_fma_f32 v34, v34, v7, v66
    v_fma_f32 v35, v35, v7, v67
    v_fma_f32 v36, v36, v7, v68
    v_fma_f32 v37, v37, v7, v69
    v_fma_f32 v38, v38, v7, v70
    v_fma_f32 v39, v39, v7, v71
    v_fma_f32 v40, v40, v7, v72
    v_fma_f32 v41, v41, v7, v73
    v_fma_f32 v42, v42, v7, v74
    v_fma_f32 v43, v43, v7, v75
    v_fma_f32 v44, v44, v7, v76
    v_fma_f32 v45, v45, v7, v77
    v_fma_f32 v46, v46, v7, v78
    v_fma_f32 v47, v47, v7, v79
    v_fma_f32 v48, v48, v7, v80
    v_fma_f32 v49, v49, v7, v81
    v_fma_f32 v50, v50, v7, v82
    v_fma_f32 v51, v51, v7, v83
    v_cvt_pk_bf16_f32 v10, v32, v33
    v_cvt_pk_bf16_f32 v11, v34, v35
    buffer_store_dwordx2 v[10:11], v9, s[24:27], 0 offen offset:0
    s_nop 0
    v_cvt_pk_bf16_f32 v10, v36, v37
    v_cvt_pk_bf16_f32 v11, v38, v39
    buffer_store_dwordx2 v[10:11], v9, s[24:27], 0 offen offset:32
    s_nop 0
    v_cvt_pk_bf16_f32 v10, v40, v41
    v_cvt_pk_bf16_f32 v11, v42, v43
    buffer_store_dwordx2 v[10:11], v9, s[24:27], 0 offen offset:64
    s_nop 0
    v_cvt_pk_bf16_f32 v10, v44, v45
    v_cvt_pk_bf16_f32 v11, v46, v47
    buffer_store_dwordx2 v[10:11], v9, s[24:27], 0 offen offset:96
    s_nop 0
    v_cvt_pk_bf16_f32 v10, v48, v49
    v_cvt_pk_bf16_f32 v11, v50, v51
    buffer_store_dwordx2 v[10:11], v9, s[24:27], 0 offen offset:128
    s_nop 0
K3_END:
    s_endpgm
.section .rodata,"a"
.p2align 6
.amdhsa_kernel qkv_kernel
  .amdhsa_next_free_vgpr 256
  .amdhsa_next_free_sgpr 102
  .amdhsa_accum_offset 256
  .amdhsa_group_segment_fixed_size 0
  .amdhsa_kernarg_size 80
  .amdhsa_user_sgpr_count 2
  .amdhsa_user_sgpr_kernarg_segment_ptr 1
  .amdhsa_system_sgpr_workgroup_id_x 1
.end_amdhsa_kernel
.p2align 6
.amdhsa_kernel attn_kernel
  .amdhsa_next_free_vgpr 244
  .amdhsa_next_free_sgpr 102
  .amdhsa_accum_offset 244
  .amdhsa_group_segment_fixed_size 0
  .amdhsa_kernarg_size 80
  .amdhsa_user_sgpr_count 2
  .amdhsa_user_sgpr_kernarg_segment_ptr 1
  .amdhsa_system_sgpr_workgroup_id_x 1
.end_amdhsa_kernel
.p2align 6
.amdhsa_kernel oproj_kernel
  .amdhsa_next_free_vgpr 168
  .amdhsa_next_free_sgpr 102
  .amdhsa_accum_offset 168
  .amdhsa_group_segment_fixed_size 0
  .amdhsa_kernarg_size 80
  .amdhsa_user_sgpr_count 2
  .amdhsa_user_sgpr_kernarg_segment_ptr 1
  .amdhsa_system_sgpr_workgroup_id_x 1
.end_amdhsa_kernel
```
